```python
import torch

def _softmax(x, axis=-1):
    return torch.softmax(x, dim=axis)
def _gelu(x):
    return torch.nn.functional.gelu(x, approximate="tanh")
def _silu(x):
    return torch.nn.functional.silu(x)
def _sigmoid(x):
    return torch.sigmoid(x)
def _layernorm(x, axis=-1, eps=1e-5):
    m = x.mean(dim=axis, keepdim=True)
    v = x.var(dim=axis, keepdim=True, unbiased=False)
    return (x - m) / torch.sqrt(v + eps)
def _scatter_add(tgt, idx, src, axis=0):
    return tgt.clone().index_add_(axis, idx, src)
def _segment_sum(src, seg, n):
    out = torch.zeros((n,) + src.shape[1:], dtype=src.dtype)
    return out.index_add_(0, seg, src)
def _pad(x, pw):
    flat = tuple(v for pair in reversed(pw) for v in pair)
    return torch.nn.functional.pad(x, flat)

kernel_name = 'standalone__paged_block_table_kv_radixattention__sampling'

def setup_inputs():

    _w = (lambda a: (lambda t: t.to(torch.bfloat16) if t.is_floating_point() else t)(torch.as_tensor(a)))
    B, H, Hkv, Dh = 8, 32, 8, 128
    Lk = 4096
    bs = 16
    nb = max(2, Lk // bs)
    P = max(1, nb // 2)
    n_phys = P + B * (nb - P)
    shared = torch.arange(P, dtype=torch.int64)
    priv = P + torch.arange(B * (nb - P), dtype=torch.int64).reshape(B, nb - P)
    bt = torch.cat([torch.tile(shared[None, :], (B, 1)), priv], dim=1)
    ctx = nb * bs - (torch.arange(1, B + 1, dtype=torch.int64) * 2654435761) % max(1, (nb * bs - P * bs) // 2)
    return {
        "q": _w((lambda *s: torch.randn(*s, dtype=torch.bfloat16) * 0.8)(B, H, Dh)),
        "k_cache": _w((lambda *s: torch.randn(*s, dtype=torch.bfloat16) * 0.8)(n_phys, bs, Hkv, Dh)),
        "v_cache": _w((lambda *s: torch.randn(*s, dtype=torch.bfloat16) * 0.05)(n_phys, bs, Hkv, Dh)),
        "block_table": _w(bt.to(torch.int64)),
        "ctx_lens": _w(torch.as_tensor(ctx).to(torch.int64)),
    }

def reference(q, k_cache, v_cache, block_table, ctx_lens):
    B, H, Dh = q.shape
    n_phys, bs, Hkv, _ = k_cache.shape
    nb = block_table.shape[1]
    Lk = nb * bs
    rep = H // Hkv
    k = k_cache[block_table].reshape(B, Lk, Hkv, Dh)
    v = v_cache[block_table].reshape(B, Lk, Hkv, Dh)
    k = (lambda x, n, axis: torch.repeat_interleave(x, n, dim=axis))(k, rep, axis=2)
    v = (lambda x, n, axis: torch.repeat_interleave(x, n, dim=axis))(v, rep, axis=2)
    scores = torch.einsum("bhd,bkhd->bhk", q, k) * (Dh ** -0.5)
    pos = torch.arange(Lk)
    valid = pos[None, :] < ctx_lens[:, None]
    scores = torch.where(valid[:, None, :], scores, -1e9)
    p = _softmax(scores, axis=-1)
    return torch.einsum("bhk,bkhd->bhd", p, v)
```

```asm
; @launch grid=(256,1,1) block=(512,1,1) lds=163840
.amdgcn_target "amdgcn-amd-amdhsa--gfx950"
.text
.globl standalone__paged_block_table_kv_radixattention__sampling_kernel
.p2align 8
.type standalone__paged_block_table_kv_radixattention__sampling_kernel,@function
standalone__paged_block_table_kv_radixattention__sampling_kernel:
    s_cmp_ge_u32 s2, 256
    s_cbranch_scc1 L_end
    s_load_dwordx16 s[4:19], s[0:1], 0
    s_getpc_b64 s[94:95]
L_pc:
    v_and_b32 v1, 63, v0
    v_lshrrev_b32 v25, 6, v0
    v_lshrrev_b32 v2, 4, v1
    v_readfirstlane_b32 s32, v25
    v_and_b32 v3, 15, v1
    s_add_u32 s3, s2, 3
    s_and_b32 s3, s3, 7
    s_lshr_b32 s33, s2, 3
    v_lshlrev_b32 v27, 4, v1
    s_lshl_b32 s70, s32, 11
    s_min_u32 s70, s70, L_end-L_pc-2048
    v_add_u32 v25, s70, v27
    global_load_dwordx4 v[128:131], v25, s[94:95]
    global_load_dwordx4 v[132:135], v25, s[94:95] offset:1024
    v_lshlrev_b32 v31, 1, v2
    v_xor_b32 v31, v31, v3
    v_lshlrev_b32 v31, 4, v31
    v_lshlrev_b32 v4, 4, v3
    v_lshl_add_u32 v4, v2, 11, v4
    v_add_u32 v5, 8192, v4
    v_add_u32 v6, 16384, v4
    v_add_u32 v7, 24576, v4
    s_and_b32 s68, s32, 1
    s_lshl_b32 s68, s68, 7
    v_xor_b32 v26, s68, v31
    v_lshl_add_u32 v26, v2, 8, v26
    v_lshlrev_b32 v27, 4, v1
    s_lshl_b32 s69, s32, 10
    v_add_u32 v28, s69, v27
    v_and_b32 v29, 7, v1
    v_lshlrev_b32 v29, 2, v29
    s_lshl_b32 s68, s32, 13
    s_lshl_b32 s70, s3, 10
    s_add_u32 s68, s68, s70
    s_add_u32 m0, s69, 114688
    s_waitcnt lgkmcnt(0)
    global_load_dwordx4 v[32:35], v28, s[10:11]
    global_load_dwordx4 v[36:39], v27, s[10:11]
    global_load_dword v19, v29, s[12:13]
    s_mov_b32 s28, s4
    s_and_b32 s29, s5, 0xffff
    s_mov_b32 s30, 65536
    s_mov_b32 s31, 0x20000
    buffer_load_dwordx4 v26, s[28:31], s68 offen lds
    s_cmp_lg_u32 s32, 7
    s_cbranch_scc1 no_1
    s_memrealtime s[92:93]
    s_lshl_b32 s68, s3, 5
    v_mov_b32 v25, s68
    v_mov_b32 v245, 0
    s_waitcnt lgkmcnt(0)
    s_xor_b32 s68, s92, s93
    s_or_b32 s68, s68, 1
    v_mov_b32 v244, s68
    s_mov_b64 exec, 1
    global_atomic_cmpswap v246, v25, v[244:245], s[16:17] sc0
    s_mov_b64 exec, -1
no_1:
    s_mov_b32 s20, s6
    s_and_b32 s21, s7, 0xffff
    s_mov_b32 s22, 37748736
    s_mov_b32 s23, 0x20000
    s_mov_b32 s24, s8
    s_and_b32 s25, s9, 0xffff
    s_mov_b32 s26, 37748736
    s_mov_b32 s27, 0x20000
    v_mov_b32 v220, 0
    v_mov_b32 v221, 0
    v_mov_b32 v222, 0
    v_mov_b32 v223, 0
    v_mov_b32 v224, 0
    v_mov_b32 v225, 0
    v_mov_b32 v226, 0
    v_mov_b32 v227, 0
    v_mov_b32 v228, 0
    v_mov_b32 v229, 0
    v_mov_b32 v230, 0
    v_mov_b32 v231, 0
    v_mov_b32 v232, 0
    v_mov_b32 v233, 0
    v_mov_b32 v234, 0
    v_mov_b32 v235, 0
    v_mov_b32 v236, 0
    v_mov_b32 v237, 0
    v_mov_b32 v238, 0
    v_mov_b32 v239, 0
    v_mov_b32 v240, 0
    v_mov_b32 v241, 0
    v_mov_b32 v247, 0
    v_mov_b32 v248, 0
    v_mov_b32 v249, 0
    v_mov_b32 v250, 0
    v_mov_b32 v251, 0
    v_and_b32 v26, 7, v3
    v_lshlrev_b32 v26, 1, v26
    v_xor_b32 v26, v26, v2
    v_lshlrev_b32 v26, 4, v26
    v_lshl_add_u32 v8, v3, 8, v26
    v_xor_b32 v9, 64, v8
    v_xor_b32 v10, 128, v8
    v_xor_b32 v11, 192, v8
    v_lshrrev_b32 v26, 2, v1
    v_and_b32 v25, 7, v26
    v_xor_b32 v25, s32, v25
    v_lshlrev_b32 v25, 5, v25
    v_lshl_add_u32 v16, v26, 8, v25
    v_and_b32 v25, 3, v1
    v_lshl_add_u32 v16, v25, 3, v16
    v_add_u32 v17, 0x10000, v16
    v_add_u32 v18, 131072, v27
    s_mov_b32 s66, 0x3e0293ee
    s_lshl_b32 s68, s32, 12
    s_add_u32 s68, s68, 131072
    v_add_u32 v12, s68, v8
    v_add_u32 v13, s68, v9
    v_add_u32 v14, s68, v10
    v_add_u32 v15, s68, v11
    v_lshl_add_u32 v192, v2, 8, v31
    v_add_u32 v192, s68, v192
    v_xor_b32 v193, 128, v192
    s_lshl_b32 s68, s3, 23
    s_add_u32 s88, s18, s68
    s_addc_u32 s89, s19, 0
    s_cmp_ge_u32 s32, 7
    s_cbranch_scc1 w7_2
    s_waitcnt vmcnt(1)
w7_2:
    s_waitcnt vmcnt(2)
    v_cmp_ne_u32 s[74:75], v32, v36
    v_cmp_ne_u32 s[76:77], v33, v37
    v_cmp_ne_u32 s[78:79], v34, v38
    v_cmp_ne_u32 s[80:81], v35, v39
    v_add_u32 v28, 122880, v28
    ds_write_b128 v28, v[32:35]
    v_min_i32 v19, 0x1000, v19
    v_max_i32 v19, 0, v19
    v_add_u32 v20, 15, v19
    v_lshrrev_b32 v20, 4, v20
    v_cmp_ne_u32 vcc, 0, v19
    v_lshrrev_b32 v21, 4, v19
    v_mov_b32 v25, 0x100
    v_cndmask_b32 v20, v25, v20, vcc
    v_add_u32 v22, 3, v20
    v_lshrrev_b32 v22, 2, v22
    v_mov_b32 v23, v22
    s_mov_b32 s68, 256
    s_ff1_i32_b64 s69, s[74:75]
    s_lshl_b32 s69, s69, 2
    v_min_u32_dpp v21, v21, v21 quad_perm:[1,0,3,2] row_mask:0xf bank_mask:0xf
    v_add_u32_dpp v23, v23, v23 row_shr:1 row_mask:0xf bank_mask:0xf bound_ctrl:0
    s_add_u32 s69, s69, 0
    s_min_u32 s68, s68, s69
    s_ff1_i32_b64 s69, s[76:77]
    s_lshl_b32 s69, s69, 2
    v_min_u32_dpp v21, v21, v21 quad_perm:[2,3,0,1] row_mask:0xf bank_mask:0xf
    v_add_u32_dpp v23, v23, v23 row_shr:2 row_mask:0xf bank_mask:0xf bound_ctrl:0
    s_add_u32 s69, s69, 1
    s_min_u32 s68, s68, s69
    s_ff1_i32_b64 s69, s[78:79]
    s_lshl_b32 s69, s69, 2
    v_min_u32_dpp v21, v21, v21 row_half_mirror row_mask:0xf bank_mask:0xf
    v_add_u32_dpp v23, v23, v23 row_shr:4 row_mask:0xf bank_mask:0xf bound_ctrl:0
    s_add_u32 s69, s69, 2
    s_min_u32 s68, s68, s69
    s_ff1_i32_b64 s69, s[80:81]
    s_lshl_b32 s69, s69, 2
    s_add_u32 s69, s69, 3
    s_min_u32 s68, s68, s69
    v_readfirstlane_b32 s70, v21
    s_lshl_b32 s69, s32, 2
    s_add_u32 s69, s69, 161792
    v_mov_b32 v26, s69
    s_min_u32 s68, s68, s70
    v_mov_b32 v25, s68
    ds_write_b32 v26, v25
    s_cmp_lg_u32 s32, 7
    s_cbranch_scc1 no_3
    v_and_b32 v26, 7, v1
    v_lshlrev_b32 v26, 2, v26
    v_add_u32 v26, 161856, v26
    v_mov_b32 v25, 0
    ds_write_b32 v26, v25
no_3:
    v_mov_b32 v29, 161792
    s_waitcnt lgkmcnt(0)
    s_barrier
    ds_read_b128 v[196:199], v29
    ds_read_b128 v[200:203], v29 offset:16
    s_waitcnt lgkmcnt(0)
    v_min3_u32 v25, v196, v197, v198
    v_min3_u32 v26, v199, v200, v201
    v_min_u32 v27, v202, v203
    v_min3_u32 v25, v25, v26, v27
    s_nop 0
    v_readfirstlane_b32 s35, v25
    s_nop 0
    s_lshr_b32 s35, s35, 2
    s_lshl_b32 s34, s35, 2
    v_mul_u32_u24 v25, s35, v1
    v_subrev_u32 v22, s35, v22
    v_sub_u32 v23, v23, v25
    v_sub_u32 v24, v23, v22
    v_readlane_b32 s36, v23, 7
    s_add_u32 s37, s36, 31
    s_lshr_b32 s37, s37, 5
    s_mov_b32 s38, 1
    s_cmp_le_u32 s37, 7
    s_cbranch_scc1 q_4
    s_add_u32 s37, s36, 63
    s_lshr_b32 s37, s37, 6
    s_mov_b32 s38, 2
    s_cmp_le_u32 s37, 7
    s_cbranch_scc1 q_4
    s_add_u32 s37, s36, 127
    s_lshr_b32 s37, s37, 7
    s_mov_b32 s38, 4
q_4:
    s_max_u32 s37, s37, 1
    s_mov_b32 s39, 0
L_round:
    s_lshl_b32 s68, s39, 5
    s_add_u32 s40, s33, s68
    s_mul_i32 s41, s40, s37
    s_cmp_ge_u32 s41, s36
    s_cbranch_scc1 L_round_next
    s_sub_u32 s42, s36, s41
    s_min_u32 s42, s42, s37
    s_add_u32 s43, s41, s32
    s_cmp_lt_u32 s32, s42
    s_cselect_b32 s82, 1, 0
    s_cbranch_scc0 L_desc
    s_cmp_ge_u32 s43, s35
    s_cbranch_scc1 priv_5
    s_lshl_b32 s45, s43, 2
    s_mov_b32 s44, 0
    s_mov_b32 s46, s34
    s_lshl_b32 s47, s34, 4
    s_mov_b32 s64, 1
    s_mov_b32 s96, 0
    s_branch got_6
priv_5:
    v_cmp_ge_u32 vcc, s43, v23
    s_nop 1
    s_and_b32 s68, vcc_lo, 0xff
    s_bcnt1_i32_b32 s44, s68
    v_readlane_b32 s69, v24, s44
    v_readlane_b32 s46, v20, s44
    v_readlane_b32 s47, v19, s44
    s_mov_b32 s64, 0
    s_lshr_b32 s96, s44, 2
    s_sub_u32 s69, s43, s69
    s_lshl_b32 s69, s69, 2
    s_add_u32 s45, s34, s69
got_6:
    v_and_b32 v25, 3, v1
    v_add_u32 v25, s45, v25
    s_lshl_b32 s68, s44, 10
    s_add_u32 s68, s68, 122880
    v_lshl_add_u32 v26, v25, 2, s68
    ds_read_b32 v26, v26
    v_cmp_gt_u32 vcc, s46, v25
    s_lshl_b32 s68, s3, 8
    v_mov_b32 v27, 37748736
    s_lshl_b32 s48, s45, 4
    s_waitcnt lgkmcnt(0)
    v_lshl_add_u32 v26, v26, 15, s68
    v_cndmask_b32 v26, v27, v26, vcc
    s_nop 0
    v_readlane_b32 s50, v26, 0
    v_readlane_b32 s51, v26, 1
    v_readlane_b32 s52, v26, 2
    v_readlane_b32 s53, v26, 3
    s_nop 1
    buffer_load_dwordx4 v[128:131], v4, s[20:23], s50 offen nt
    buffer_load_dwordx4 v[132:135], v5, s[20:23], s50 offen nt
    buffer_load_dwordx4 v[136:139], v6, s[20:23], s50 offen nt
    buffer_load_dwordx4 v[140:143], v7, s[20:23], s50 offen nt
    buffer_load_dwordx4 v[144:147], v4, s[20:23], s51 offen nt
    buffer_load_dwordx4 v[148:151], v5, s[20:23], s51 offen nt
    buffer_load_dwordx4 v[152:155], v6, s[20:23], s51 offen nt
    buffer_load_dwordx4 v[156:159], v7, s[20:23], s51 offen nt
    buffer_load_dwordx4 v[160:163], v4, s[20:23], s52 offen nt
    buffer_load_dwordx4 v[164:167], v5, s[20:23], s52 offen nt
    buffer_load_dwordx4 v[168:171], v6, s[20:23], s52 offen nt
    buffer_load_dwordx4 v[172:175], v7, s[20:23], s52 offen nt
    buffer_load_dwordx4 v[176:179], v4, s[20:23], s53 offen nt
    buffer_load_dwordx4 v[180:183], v5, s[20:23], s53 offen nt
    buffer_load_dwordx4 v[184:187], v6, s[20:23], s53 offen nt
    buffer_load_dwordx4 v[188:191], v7, s[20:23], s53 offen nt
L_desc:
    s_add_u32 s70, s41, 0
    v_cmp_ge_u32 vcc, s70, v23
    s_cmp_ge_u32 s70, s35
    s_cselect_b32 s71, 1, 0
    s_and_b32 s72, vcc_lo, 0xff
    s_bcnt1_i32_b32 s72, s72
    s_add_u32 s54, s71, s72
    s_add_u32 s70, s41, 1
    v_cmp_ge_u32 vcc, s70, v23
    s_cmp_ge_u32 s70, s35
    s_cselect_b32 s71, 1, 0
    s_and_b32 s72, vcc_lo, 0xff
    s_bcnt1_i32_b32 s72, s72
    s_add_u32 s55, s71, s72
    s_add_u32 s70, s41, 2
    v_cmp_ge_u32 vcc, s70, v23
    s_cmp_ge_u32 s70, s35
    s_cselect_b32 s71, 1, 0
    s_and_b32 s72, vcc_lo, 0xff
    s_bcnt1_i32_b32 s72, s72
    s_add_u32 s56, s71, s72
    s_add_u32 s70, s41, 3
    v_cmp_ge_u32 vcc, s70, v23
    s_cmp_ge_u32 s70, s35
    s_cselect_b32 s71, 1, 0
    s_and_b32 s72, vcc_lo, 0xff
    s_bcnt1_i32_b32 s72, s72
    s_add_u32 s57, s71, s72
    s_add_u32 s70, s41, 4
    v_cmp_ge_u32 vcc, s70, v23
    s_cmp_ge_u32 s70, s35
    s_cselect_b32 s71, 1, 0
    s_and_b32 s72, vcc_lo, 0xff
    s_bcnt1_i32_b32 s72, s72
    s_add_u32 s58, s71, s72
    s_add_u32 s70, s41, 5
    v_cmp_ge_u32 vcc, s70, v23
    s_cmp_ge_u32 s70, s35
    s_cselect_b32 s71, 1, 0
    s_and_b32 s72, vcc_lo, 0xff
    s_bcnt1_i32_b32 s72, s72
    s_add_u32 s59, s71, s72
    s_add_u32 s70, s41, 6
    v_cmp_ge_u32 vcc, s70, v23
    s_cmp_ge_u32 s70, s35
    s_cselect_b32 s71, 1, 0
    s_and_b32 s72, vcc_lo, 0xff
    s_bcnt1_i32_b32 s72, s72
    s_add_u32 s60, s71, s72
    s_mov_b32 s61, 1
    s_cmp_lg_u32 s55, s54
    s_cselect_b32 s70, 2, 0
    s_or_b32 s61, s61, s70
    s_cmp_lg_u32 s56, s55
    s_cselect_b32 s70, 4, 0
    s_or_b32 s61, s61, s70
    s_cmp_lg_u32 s57, s56
    s_cselect_b32 s70, 8, 0
    s_or_b32 s61, s61, s70
    s_cmp_lg_u32 s58, s57
    s_cselect_b32 s70, 16, 0
    s_or_b32 s61, s61, s70
    s_cmp_lg_u32 s59, s58
    s_cselect_b32 s70, 32, 0
    s_or_b32 s61, s61, s70
    s_cmp_lg_u32 s60, s59
    s_cselect_b32 s70, 64, 0
    s_or_b32 s61, s61, s70
    s_lshl_b32 s70, 1, s42
    s_sub_u32 s70, s70, 1
    s_and_b32 s63, s61, s70
    s_andn2_b32 s71, 0xff, s70
    s_or_b32 s61, s61, s71
    s_lshr_b32 s62, s61, 1
    s_cmp_lt_u32 s41, s35
    s_cselect_b32 s65, 1, 0
    s_lshl_b32 s70, 2, s32
    s_sub_u32 s70, s70, 1
    s_and_b32 s70, s70, s61
    s_flbit_i32_b32 s70, s70
    s_sub_u32 s98, 31, s70
    s_lshr_b32 s70, s62, s32
    s_ff1_i32_b32 s70, s70
    s_add_u32 s99, s70, s32
    s_lshl_b32 s70, 2, s99
    s_sub_u32 s70, s70, 1
    s_lshl_b32 s71, 1, s98
    s_sub_u32 s71, s71, 1
    s_andn2_b32 s49, s70, s71
    v_cvt_f32_u32 v25, s37
    s_nop 0
    v_rcp_f32 v25, v25
    s_nop 0
    v_mul_f32 v25, 0x47800000, v25
    v_ceil_f32 v25, v25
    v_cvt_u32_f32 v25, v25
    s_nop 0
    v_readfirstlane_b32 s83, v25
    s_sub_u32 s70, s35, 1
    s_mul_i32 s70, s70, s83
    s_lshr_b32 s70, s70, 16
    s_add_u32 s70, s70, 1
    s_cmp_eq_u32 s35, 0
    s_cselect_b32 s84, 0, s70
    v_mul_u32_u24 v29, s83, v24
    v_lshrrev_b32 v29, 16, v29
    v_subrev_u32 v30, 1, v23
    v_mul_u32_u24 v30, s83, v30
    v_lshrrev_b32 v30, 16, v30
    v_sub_u32 v30, v30, v29
    v_add_u32 v30, 1, v30
    v_cmp_ne_u32 vcc, 0, v22
    s_nop 1
    v_cndmask_b32 v30, 0, v30, vcc
    v_add_u32 v25, v29, v30
    v_subrev_u32 v25, 1, v25
    s_sub_u32 s70, s84, 1
    v_mov_b32 v26, s70
    v_cndmask_b32 v25, v26, v25, vcc
    v_cmp_eq_u32 vcc, s40, v25
    s_nop 1
    s_and_b32 s100, vcc_lo, 0xff
    s_cmp_eq_u32 s32, 7
    s_cbranch_scc1 L_service
    s_cmp_eq_u32 s82, 1
    s_cbranch_scc1 kb_7
    s_waitcnt vmcnt(0)
kb_7:
    s_waitcnt vmcnt(16)
    s_barrier
    s_cmp_eq_u32 s82, 0
    s_cbranch_scc1 L_b2
    s_lshl_b32 s69, s96, 12
    s_add_u32 s69, s69, 114688
    v_add_u32 v196, s69, v8
    v_add_u32 v197, s69, v9
    v_add_u32 v198, s69, v10
    v_add_u32 v199, s69, v11
    ds_read_b128 v[32:35], v196
    ds_read_b128 v[36:39], v197
    ds_read_b128 v[40:43], v198
    ds_read_b128 v[44:47], v199
    ds_read_b128 v[48:51], v196 offset:4096
    ds_read_b128 v[52:55], v197 offset:4096
    ds_read_b128 v[56:59], v198 offset:4096
    ds_read_b128 v[60:63], v199 offset:4096
    v_lshl_add_u32 v4, v2, 11, v31
    v_xor_b32 v5, 128, v4
    v_add_u32 v6, 14336, v4
    v_add_u32 v5, 7168, v5
    v_add_u32 v7, 14336, v5
    s_lshl_b32 s68, s32, 14
    s_add_u32 m0, s68, 0
    s_nop 0
    buffer_load_dwordx4 v4, s[24:27], s50 offen offset:0 nt lds
    buffer_load_dwordx4 v5, s[24:27], s50 offen offset:1024 nt lds
    buffer_load_dwordx4 v6, s[24:27], s50 offen offset:2048 nt lds
    buffer_load_dwordx4 v7, s[24:27], s50 offen offset:3072 nt lds
    s_add_u32 m0, s68, 4096
    s_nop 0
    buffer_load_dwordx4 v4, s[24:27], s51 offen offset:0 nt lds
    buffer_load_dwordx4 v5, s[24:27], s51 offen offset:1024 nt lds
    buffer_load_dwordx4 v6, s[24:27], s51 offen offset:2048 nt lds
    buffer_load_dwordx4 v7, s[24:27], s51 offen offset:3072 nt lds
    s_waitcnt lgkmcnt(0)
    s_cmp_eq_u32 s64, 1
    s_cbranch_scc1 L_qk2
    s_waitcnt vmcnt(20)
    ds_write_b128 v192, v[128:131] offset:0
    ds_write_b128 v193, v[132:135] offset:1024
    ds_write_b128 v192, v[136:139] offset:2048
    ds_write_b128 v193, v[140:143] offset:3072
    ds_read_b128 v[64:67], v12
    ds_read_b128 v[68:71], v13
    ds_read_b128 v[72:75], v14
    ds_read_b128 v[76:79], v15
    s_waitcnt lgkmcnt(0)
    v_mfma_f32_16x16x32_bf16 v[96:99], v[64:67], v[32:35], 0
    v_mfma_f32_16x16x32_bf16 v[96:99], v[68:71], v[36:39], v[96:99]
    v_mfma_f32_16x16x32_bf16 v[96:99], v[72:75], v[40:43], v[96:99]
    v_mfma_f32_16x16x32_bf16 v[96:99], v[76:79], v[44:47], v[96:99]
    s_waitcnt vmcnt(16)
    ds_write_b128 v192, v[144:147] offset:0
    ds_write_b128 v193, v[148:151] offset:1024
    ds_write_b128 v192, v[152:155] offset:2048
    ds_write_b128 v193, v[156:159] offset:3072
    ds_read_b128 v[80:83], v12
    ds_read_b128 v[84:87], v13
    ds_read_b128 v[88:91], v14
    ds_read_b128 v[92:95], v15
    s_waitcnt lgkmcnt(0)
    v_mfma_f32_16x16x32_bf16 v[100:103], v[80:83], v[32:35], 0
    v_mfma_f32_16x16x32_bf16 v[100:103], v[84:87], v[36:39], v[100:103]
    v_mfma_f32_16x16x32_bf16 v[100:103], v[88:91], v[40:43], v[100:103]
    v_mfma_f32_16x16x32_bf16 v[100:103], v[92:95], v[44:47], v[100:103]
    s_waitcnt vmcnt(12)
    ds_write_b128 v192, v[160:163] offset:0
    ds_write_b128 v193, v[164:167] offset:1024
    ds_write_b128 v192, v[168:171] offset:2048
    ds_write_b128 v193, v[172:175] offset:3072
    ds_read_b128 v[64:67], v12
    ds_read_b128 v[68:71], v13
    ds_read_b128 v[72:75], v14
    ds_read_b128 v[76:79], v15
    s_waitcnt lgkmcnt(0)
    v_mfma_f32_16x16x32_bf16 v[104:107], v[64:67], v[32:35], 0
    v_mfma_f32_16x16x32_bf16 v[104:107], v[68:71], v[36:39], v[104:107]
    v_mfma_f32_16x16x32_bf16 v[104:107], v[72:75], v[40:43], v[104:107]
    v_mfma_f32_16x16x32_bf16 v[104:107], v[76:79], v[44:47], v[104:107]
    s_waitcnt vmcnt(8)
    ds_write_b128 v192, v[176:179] offset:0
    ds_write_b128 v193, v[180:183] offset:1024
    ds_write_b128 v192, v[184:187] offset:2048
    ds_write_b128 v193, v[188:191] offset:3072
    ds_read_b128 v[80:83], v12
    ds_read_b128 v[84:87], v13
    ds_read_b128 v[88:91], v14
    ds_read_b128 v[92:95], v15
    s_waitcnt lgkmcnt(0)
    v_mfma_f32_16x16x32_bf16 v[108:111], v[80:83], v[32:35], 0
    v_mfma_f32_16x16x32_bf16 v[108:111], v[84:87], v[36:39], v[108:111]
    v_mfma_f32_16x16x32_bf16 v[108:111], v[88:91], v[40:43], v[108:111]
    v_mfma_f32_16x16x32_bf16 v[108:111], v[92:95], v[44:47], v[108:111]
    s_nop 7
    v_mul_f32 v96, s66, v96
    v_mul_f32 v97, s66, v97
    v_mul_f32 v98, s66, v98
    v_mul_f32 v99, s66, v99
    v_mul_f32 v100, s66, v100
    v_mul_f32 v101, s66, v101
    v_mul_f32 v102, s66, v102
    v_mul_f32 v103, s66, v103
    v_mul_f32 v104, s66, v104
    v_mul_f32 v105, s66, v105
    v_mul_f32 v106, s66, v106
    v_mul_f32 v107, s66, v107
    v_mul_f32 v108, s66, v108
    v_mul_f32 v109, s66, v109
    v_mul_f32 v110, s66, v110
    v_mul_f32 v111, s66, v111
    s_add_u32 s69, s48, 64
    s_cmp_le_u32 s69, s47
    s_cbranch_scc1 nomask_8
    v_lshl_add_u32 v25, v2, 2, s48
    v_mov_b32 v26, 0xceabfb8f
    v_add_u32 v27, 0, v25
    v_cmp_gt_u32 vcc, s47, v27
    s_nop 1
    v_cndmask_b32 v96, v26, v96, vcc
    v_add_u32 v27, 1, v25
    v_cmp_gt_u32 vcc, s47, v27
    s_nop 1
    v_cndmask_b32 v97, v26, v97, vcc
    v_add_u32 v27, 2, v25
    v_cmp_gt_u32 vcc, s47, v27
    s_nop 1
    v_cndmask_b32 v98, v26, v98, vcc
    v_add_u32 v27, 3, v25
    v_cmp_gt_u32 vcc, s47, v27
    s_nop 1
    v_cndmask_b32 v99, v26, v99, vcc
    v_add_u32 v27, 16, v25
    v_cmp_gt_u32 vcc, s47, v27
    s_nop 1
    v_cndmask_b32 v100, v26, v100, vcc
    v_add_u32 v27, 17, v25
    v_cmp_gt_u32 vcc, s47, v27
    s_nop 1
    v_cndmask_b32 v101, v26, v101, vcc
    v_add_u32 v27, 18, v25
    v_cmp_gt_u32 vcc, s47, v27
    s_nop 1
    v_cndmask_b32 v102, v26, v102, vcc
    v_add_u32 v27, 19, v25
    v_cmp_gt_u32 vcc, s47, v27
    s_nop 1
    v_cndmask_b32 v103, v26, v103, vcc
    v_add_u32 v27, 32, v25
    v_cmp_gt_u32 vcc, s47, v27
    s_nop 1
    v_cndmask_b32 v104, v26, v104, vcc
    v_add_u32 v27, 33, v25
    v_cmp_gt_u32 vcc, s47, v27
    s_nop 1
    v_cndmask_b32 v105, v26, v105, vcc
    v_add_u32 v27, 34, v25
    v_cmp_gt_u32 vcc, s47, v27
    s_nop 1
    v_cndmask_b32 v106, v26, v106, vcc
    v_add_u32 v27, 35, v25
    v_cmp_gt_u32 vcc, s47, v27
    s_nop 1
    v_cndmask_b32 v107, v26, v107, vcc
    v_add_u32 v27, 48, v25
    v_cmp_gt_u32 vcc, s47, v27
    s_nop 1
    v_cndmask_b32 v108, v26, v108, vcc
    v_add_u32 v27, 49, v25
    v_cmp_gt_u32 vcc, s47, v27
    s_nop 1
    v_cndmask_b32 v109, v26, v109, vcc
    v_add_u32 v27, 50, v25
    v_cmp_gt_u32 vcc, s47, v27
    s_nop 1
    v_cndmask_b32 v110, v26, v110, vcc
    v_add_u32 v27, 51, v25
    v_cmp_gt_u32 vcc, s47, v27
    s_nop 1
    v_cndmask_b32 v111, v26, v111, vcc
nomask_8:
    v_max3_f32 v196, v96, v97, v98
    v_max3_f32 v196, v196, v99, v100
    v_max3_f32 v196, v196, v101, v102
    v_max3_f32 v196, v196, v103, v104
    v_max3_f32 v196, v196, v105, v106
    v_max3_f32 v196, v196, v107, v108
    v_max3_f32 v196, v196, v109, v110
    v_max_f32 v196, v196, v111
    v_mov_b32 v198, v196
    s_nop 1
    v_permlane32_swap_b32 v198, v196
    s_nop 1
    v_max_f32 v196, v196, v198
    v_mov_b32 v198, v196
    s_nop 1
    v_permlane16_swap_b32 v198, v196
    s_nop 1
    v_max_f32 v196, v196, v198
    s_lshl_b32 s69, s32, 7
    s_add_u32 s69, s69, 159744
    v_lshl_add_u32 v25, v3, 2, s69
    ds_write_b32 v25, v196 offset:0
    s_add_u32 s70, s39, 1
    s_lshl_b32 s69, s32, 2
    s_add_u32 s69, s69, 161856
    v_mov_b32 v26, s69
    v_mov_b32 v27, s70
    ds_write_b32 v26, v27
    v_and_b32 v26, 7, v1
    v_lshlrev_b32 v26, 2, v26
    v_add_u32 v26, 161856, v26
fp_9:
    ds_read_b32 v27, v26
    s_waitcnt lgkmcnt(0)
    v_cmp_ne_u32 vcc, s70, v27
    s_nop 1
    s_and_b32 s69, vcc_lo, s49
    s_cbranch_scc1 fp_9
    v_lshlrev_b32 v26, 2, v3
    v_add_u32 v26, 159744, v26
    ds_read_b32 v200, v26 offset:0
    ds_read_b32 v202, v26 offset:128
    ds_read_b32 v204, v26 offset:256
    ds_read_b32 v206, v26 offset:384
    ds_read_b32 v208, v26 offset:512
    ds_read_b32 v210, v26 offset:640
    ds_read_b32 v212, v26 offset:768
    s_waitcnt lgkmcnt(0)
    s_bitcmp1_b32 s49, 0
    s_cbranch_scc0 pm_10
    v_max_f32 v196, v196, v200
pm_10:
    s_bitcmp1_b32 s49, 1
    s_cbranch_scc0 pm_11
    v_max_f32 v196, v196, v202
pm_11:
    s_bitcmp1_b32 s49, 2
    s_cbranch_scc0 pm_12
    v_max_f32 v196, v196, v204
pm_12:
    s_bitcmp1_b32 s49, 3
    s_cbranch_scc0 pm_13
    v_max_f32 v196, v196, v206
pm_13:
    s_bitcmp1_b32 s49, 4
    s_cbranch_scc0 pm_14
    v_max_f32 v196, v196, v208
pm_14:
    s_bitcmp1_b32 s49, 5
    s_cbranch_scc0 pm_15
    v_max_f32 v196, v196, v210
pm_15:
    s_bitcmp1_b32 s49, 6
    s_cbranch_scc0 pm_16
    v_max_f32 v196, v196, v212
pm_16:
    ds_write_b32 v25, v196 offset:3072
    v_sub_f32 v96, v96, v196
    v_sub_f32 v97, v97, v196
    v_sub_f32 v98, v98, v196
    v_sub_f32 v99, v99, v196
    v_sub_f32 v100, v100, v196
    v_sub_f32 v101, v101, v196
    v_sub_f32 v102, v102, v196
    v_sub_f32 v103, v103, v196
    v_sub_f32 v104, v104, v196
    v_sub_f32 v105, v105, v196
    v_sub_f32 v106, v106, v196
    v_sub_f32 v107, v107, v196
    v_sub_f32 v108, v108, v196
    v_sub_f32 v109, v109, v196
    v_sub_f32 v110, v110, v196
    v_sub_f32 v111, v111, v196
    v_exp_f32 v96, v96
    v_exp_f32 v97, v97
    v_exp_f32 v98, v98
    v_exp_f32 v99, v99
    v_exp_f32 v100, v100
    v_exp_f32 v101, v101
    v_exp_f32 v102, v102
    v_exp_f32 v103, v103
    v_exp_f32 v104, v104
    v_exp_f32 v105, v105
    v_exp_f32 v106, v106
    v_exp_f32 v107, v107
    v_exp_f32 v108, v108
    v_exp_f32 v109, v109
    v_exp_f32 v110, v110
    v_exp_f32 v111, v111
    s_nop 0
    v_cvt_pk_bf16_f32 v64, v96, v97
    v_cvt_pk_bf16_f32 v65, v98, v99
    v_cvt_pk_bf16_f32 v66, v100, v101
    v_cvt_pk_bf16_f32 v67, v102, v103
    v_cvt_pk_bf16_f32 v68, v104, v105
    v_cvt_pk_bf16_f32 v69, v106, v107
    v_cvt_pk_bf16_f32 v70, v108, v109
    v_cvt_pk_bf16_f32 v71, v110, v111
    s_lshl_b32 s69, s32, 12
    v_add_u32 v26, s69, v18
    ds_write_b128 v26, v[64:67] offset:0
    ds_write_b128 v26, v[68:71] offset:2048
    v_add_f32 v200, v96, v97
    v_add_f32 v200, v200, v98
    v_add_f32 v200, v200, v99
    v_add_f32 v200, v200, v100
    v_add_f32 v200, v200, v101
    v_add_f32 v200, v200, v102
    v_add_f32 v200, v200, v103
    v_add_f32 v200, v200, v104
    v_add_f32 v200, v200, v105
    v_add_f32 v200, v200, v106
    v_add_f32 v200, v200, v107
    v_add_f32 v200, v200, v108
    v_add_f32 v200, v200, v109
    v_add_f32 v200, v200, v110
    v_add_f32 v200, v200, v111
    v_mov_b32 v202, v200
    s_nop 1
    v_permlane32_swap_b32 v202, v200
    s_nop 1
    v_add_f32 v200, v200, v202
    v_mov_b32 v202, v200
    s_nop 1
    v_permlane16_swap_b32 v202, v200
    s_nop 1
    v_add_f32 v200, v200, v202
    ds_write_b32 v25, v200 offset:1024
    s_waitcnt vmcnt(0) lgkmcnt(0)
L_b2:
    s_barrier
    v_mov_b32 v26, 161920
    ds_read_b32 v26, v26
    s_cmp_eq_u32 s65, 1
    s_cbranch_scc1 L_pv2
    ds_read_b128 v[64:67], v18 offset:0
    ds_read_b128 v[72:75], v18 offset:4096
    ds_read_b128 v[80:83], v18 offset:8192
    ds_read_b128 v[88:91], v18 offset:12288
    ds_read_b128 v[96:99], v18 offset:16384
    ds_read_b128 v[104:107], v18 offset:20480
    ds_read_b128 v[112:115], v18 offset:24576
    ds_read_b64_tr_b16 v[32:33], v16 offset:0
    ds_read_b64_tr_b16 v[34:35], v16 offset:4096
    ds_read_b64_tr_b16 v[36:37], v16 offset:16384
    ds_read_b64_tr_b16 v[38:39], v16 offset:20480
    ds_read_b64_tr_b16 v[40:41], v16 offset:32768
    ds_read_b64_tr_b16 v[42:43], v16 offset:36864
    ds_read_b64_tr_b16 v[44:45], v16 offset:49152
    ds_read_b64_tr_b16 v[46:47], v16 offset:53248
    ds_read_b64_tr_b16 v[48:49], v17 offset:0
    ds_read_b64_tr_b16 v[50:51], v17 offset:4096
    ds_read_b64_tr_b16 v[52:53], v17 offset:16384
    ds_read_b64_tr_b16 v[54:55], v17 offset:20480
    ds_read_b64_tr_b16 v[56:57], v17 offset:32768
    ds_read_b64_tr_b16 v[58:59], v17 offset:36864
    s_waitcnt lgkmcnt(0)
    v_readfirstlane_b32 s67, v26
    s_bitcmp1_b32 s61, 0
    s_cbranch_scc1 fa_27
fa_27:
    v_mfma_f32_16x16x32_bf16 v[128:131], v[32:35], v[64:67], 0
fb_28:
    s_bitcmp1_b32 s61, 1
    s_cbranch_scc1 fa_29
    v_mfma_f32_16x16x32_bf16 v[136:139], v[36:39], v[72:75], v[128:131]
    s_branch fb_30
fa_29:
    v_mfma_f32_16x16x32_bf16 v[136:139], v[36:39], v[72:75], 0
fb_30:
    s_bitcmp1_b32 s61, 2
    s_cbranch_scc1 fa_31
    v_mfma_f32_16x16x32_bf16 v[144:147], v[40:43], v[80:83], v[136:139]
    s_branch fb_32
fa_31:
    v_mfma_f32_16x16x32_bf16 v[144:147], v[40:43], v[80:83], 0
fb_32:
    s_bitcmp1_b32 s61, 3
    s_cbranch_scc1 fa_33
    v_mfma_f32_16x16x32_bf16 v[152:155], v[44:47], v[88:91], v[144:147]
    s_branch fb_34
fa_33:
    v_mfma_f32_16x16x32_bf16 v[152:155], v[44:47], v[88:91], 0
fb_34:
    s_bitcmp1_b32 s61, 4
    s_cbranch_scc1 fa_35
    v_mfma_f32_16x16x32_bf16 v[160:163], v[48:51], v[96:99], v[152:155]
    s_branch fb_36
fa_35:
    v_mfma_f32_16x16x32_bf16 v[160:163], v[48:51], v[96:99], 0
fb_36:
    s_bitcmp1_b32 s61, 5
    s_cbranch_scc1 fa_37
    v_mfma_f32_16x16x32_bf16 v[168:171], v[52:55], v[104:107], v[160:163]
    s_branch fb_38
fa_37:
    v_mfma_f32_16x16x32_bf16 v[168:171], v[52:55], v[104:107], 0
fb_38:
    s_bitcmp1_b32 s61, 6
    s_cbranch_scc1 fa_39
    v_mfma_f32_16x16x32_bf16 v[176:179], v[56:59], v[112:115], v[168:171]
    s_branch fb_40
fa_39:
    v_mfma_f32_16x16x32_bf16 v[176:179], v[56:59], v[112:115], 0
fb_40:
    ds_read_b128 v[64:67], v18 offset:2048
    ds_read_b128 v[72:75], v18 offset:6144
    ds_read_b128 v[80:83], v18 offset:10240
    ds_read_b128 v[88:91], v18 offset:14336
    ds_read_b128 v[96:99], v18 offset:18432
    ds_read_b128 v[104:107], v18 offset:22528
    ds_read_b128 v[112:115], v18 offset:26624
    s_mov_b32 s91, 0
    s_cmp_eq_u32 s100, 0
    s_cbranch_scc1 pt_41
    s_ff1_i32_b32 s97, s100
    v_readlane_b32 s85, v29, s97
    v_readlane_b32 s86, v30, s97
    s_nop 0
    s_add_u32 s87, s84, s86
    s_mov_b32 s101, 0
    v_lshrrev_b32 v250, 2, v1
    v_and_b32 v250, 3, v250
    v_and_b32 v219, 3, v1
    v_lshl_add_u32 v219, v2, 2, v219
    s_add_u32 s68, s85, s97
    s_add_u32 s68, s68, 1
    s_sub_u32 s68, s68, s84
    s_sub_u32 s69, s87, 1
    s_lshl_b32 s70, s32, 8
    s_add_u32 s70, s70, 4194304
    v_add_u32 v216, s101, v250
    v_add_u32 v216, 0, v216
    v_cmp_lt_u32 vcc, s69, v216
    v_min_u32 v216, s69, v216
    v_mov_b32 v218, s97
    v_cndmask_b32 v247, 0, 1, vcc
    v_cmp_gt_u32 vcc, s84, v216
    v_add_u32 v217, s68, v216
    s_nop 0
    v_cndmask_b32 v217, v217, v216, vcc
    v_cndmask_b32 v218, 0, v218, vcc
    v_lshlrev_b32 v232, 14, v217
    v_lshl_add_u32 v232, v218, 11, v232
    v_lshl_add_u32 v232, v219, 4, v232
    v_add_u32 v232, s70, v232
    v_lshlrev_b32 v235, 9, v217
    v_lshl_add_u32 v235, v218, 6, v235
    v_and_b32 v217, 3, v1
    v_lshl_add_u32 v235, v217, 4, v235
    v_add_u32 v235, 7340032, v235
    v_add_u32 v216, s101, v250
    v_add_u32 v216, 4, v216
    v_cmp_lt_u32 vcc, s69, v216
    v_min_u32 v216, s69, v216
    v_mov_b32 v218, s97
    v_cndmask_b32 v248, 0, 1, vcc
    v_cmp_gt_u32 vcc, s84, v216
    v_add_u32 v217, s68, v216
    s_nop 0
    v_cndmask_b32 v217, v217, v216, vcc
    v_cndmask_b32 v218, 0, v218, vcc
    v_lshlrev_b32 v233, 14, v217
    v_lshl_add_u32 v233, v218, 11, v233
    v_lshl_add_u32 v233, v219, 4, v233
    v_add_u32 v233, s70, v233
    v_lshlrev_b32 v236, 9, v217
    v_lshl_add_u32 v236, v218, 6, v236
    v_and_b32 v217, 3, v1
    v_lshl_add_u32 v236, v217, 4, v236
    v_add_u32 v236, 7340032, v236
    v_add_u32 v216, s101, v250
    v_add_u32 v216, 8, v216
    v_cmp_lt_u32 vcc, s69, v216
    v_min_u32 v216, s69, v216
    v_mov_b32 v218, s97
    v_cndmask_b32 v249, 0, 1, vcc
    v_cmp_gt_u32 vcc, s84, v216
    v_add_u32 v217, s68, v216
    s_nop 0
    v_cndmask_b32 v217, v217, v216, vcc
    v_cndmask_b32 v218, 0, v218, vcc
    v_lshlrev_b32 v234, 14, v217
    v_lshl_add_u32 v234, v218, 11, v234
    v_lshl_add_u32 v234, v219, 4, v234
    v_add_u32 v234, s70, v234
    v_lshlrev_b32 v237, 9, v217
    v_lshl_add_u32 v237, v218, 6, v237
    v_and_b32 v217, 3, v1
    v_lshl_add_u32 v237, v217, 4, v237
    v_add_u32 v237, 7340032, v237
    s_mov_b32 s91, 1
    s_cmp_eq_u32 s32, 7
    s_cbranch_scc1 pt_41
    v_add_u32 v216, 0, v250
    v_cmp_gt_u32 vcc, s84, v216
    s_nop 1
    s_mov_b64 exec, vcc
    s_cbranch_execz ptk_44
    global_load_dwordx4 v[120:123], v232, s[88:89] sc1
    s_cmp_lg_u32 s32, 6
    s_cbranch_scc1 ptk_44
    global_load_dwordx4 v[120:123], v232, s[88:89] offset:256 sc1
ptk_44:
    s_mov_b64 exec, -1
    v_add_u32 v216, 4, v250
    v_cmp_gt_u32 vcc, s84, v216
    s_nop 1
    s_mov_b64 exec, vcc
    s_cbranch_execz ptk_45
    global_load_dwordx4 v[120:123], v233, s[88:89] sc1
    s_cmp_lg_u32 s32, 6
    s_cbranch_scc1 ptk_45
    global_load_dwordx4 v[120:123], v233, s[88:89] offset:256 sc1
ptk_45:
    s_mov_b64 exec, -1
    v_add_u32 v216, 8, v250
    v_cmp_gt_u32 vcc, s84, v216
    s_nop 1
    s_mov_b64 exec, vcc
    s_cbranch_execz ptk_46
    global_load_dwordx4 v[120:123], v234, s[88:89] sc1
    s_cmp_lg_u32 s32, 6
    s_cbranch_scc1 ptk_46
    global_load_dwordx4 v[120:123], v234, s[88:89] offset:256 sc1
ptk_46:
    s_mov_b64 exec, -1
    s_cmp_lg_u32 s32, 0
    s_cbranch_scc1 pt_41
    global_load_dwordx4 v[120:123], v235, s[88:89] sc1
    global_load_dwordx4 v[120:123], v236, s[88:89] sc1
    global_load_dwordx4 v[120:123], v237, s[88:89] sc1
pt_41:
    s_lshl_b32 s68, s32, 8
    v_and_b32 v220, 3, v3
    v_lshl_add_u32 v220, v2, 2, v220
    v_lshlrev_b32 v220, 4, v220
    v_add_u32 v220, s68, v220
    v_lshrrev_b32 v221, 2, v3
    v_mov_b32 v225, s67
    v_mov_b32 v227, s67
    v_mov_b32 v229, s67
    v_mov_b32 v231, s67
    s_add_u32 s69, s40, s54
    s_lshl_b32 s70, s69, 14
    s_cmp_lg_u32 s54, 0
    s_cbranch_scc1 p0_47
    v_lshl_add_u32 v240, v221, 11, v220
    v_add_u32 v240, s70, v240
    s_mov_b64 s[94:95], -1
    s_mov_b32 s73, 1
    s_branch p1_48
p0_47:
    s_sub_u32 s71, s54, 1
    s_and_b32 s69, s71, 3
    v_add_u32 v240, s70, v220
    v_cmp_eq_u32 s[94:95], s69, v221
    s_bitcmp1_b32 s100, s71
    s_cselect_b32 s73, 0, 1
p1_48:
    v_add_u32 v238, 4194304, v240
    v_add_u32 v241, 0x2000, v240
    v_add_u32 v239, 0x2000, v238
    s_cmp_eq_u32 s32, 7
    s_cbranch_scc1 pp_49
    s_bitcmp1_b32 s63, 0
    s_cbranch_scc0 ppn_50
    s_cmp_eq_u32 s54, 0
    s_cbranch_scc1 ppn_50
    s_add_u32 s69, s40, s54
    s_lshl_b32 s70, s69, 14
    s_add_u32 s70, s70, 4194304
    v_add_u32 v223, s70, v220
    s_mov_b32 exec_lo, 0x000f000f
    s_mov_b32 exec_hi, 0x000f000f
    global_load_dwordx4 v[120:123], v223, s[88:89] sc1
    s_cmp_lg_u32 s32, 6
    s_cbranch_scc1 pp6_51
    global_load_dwordx4 v[120:123], v223, s[88:89] offset:256 sc1
pp6_51:
    s_mov_b64 exec, -1
ppn_50:
    s_bitcmp1_b32 s63, 1
    s_cbranch_scc0 ppn_52
    s_cmp_eq_u32 s55, 0
    s_cbranch_scc1 ppn_52
    s_add_u32 s69, s40, s55
    s_lshl_b32 s70, s69, 14
    s_add_u32 s70, s70, 4194304
    v_add_u32 v223, s70, v220
    s_mov_b32 exec_lo, 0x000f000f
    s_mov_b32 exec_hi, 0x000f000f
    global_load_dwordx4 v[120:123], v223, s[88:89] sc1
    s_cmp_lg_u32 s32, 6
    s_cbranch_scc1 pp6_53
    global_load_dwordx4 v[120:123], v223, s[88:89] offset:256 sc1
pp6_53:
    s_mov_b64 exec, -1
ppn_52:
    s_bitcmp1_b32 s63, 2
    s_cbranch_scc0 ppn_54
    s_cmp_eq_u32 s56, 0
    s_cbranch_scc1 ppn_54
    s_add_u32 s69, s40, s56
    s_lshl_b32 s70, s69, 14
    s_add_u32 s70, s70, 4194304
    v_add_u32 v223, s70, v220
    s_mov_b32 exec_lo, 0x000f000f
    s_mov_b32 exec_hi, 0x000f000f
    global_load_dwordx4 v[120:123], v223, s[88:89] sc1
    s_cmp_lg_u32 s32, 6
    s_cbranch_scc1 pp6_55
    global_load_dwordx4 v[120:123], v223, s[88:89] offset:256 sc1
pp6_55:
    s_mov_b64 exec, -1
ppn_54:
    s_bitcmp1_b32 s63, 3
    s_cbranch_scc0 ppn_56
    s_cmp_eq_u32 s57, 0
    s_cbranch_scc1 ppn_56
    s_add_u32 s69, s40, s57
    s_lshl_b32 s70, s69, 14
    s_add_u32 s70, s70, 4194304
    v_add_u32 v223, s70, v220
    s_mov_b32 exec_lo, 0x000f000f
    s_mov_b32 exec_hi, 0x000f000f
    global_load_dwordx4 v[120:123], v223, s[88:89] sc1
    s_cmp_lg_u32 s32, 6
    s_cbranch_scc1 pp6_57
    global_load_dwordx4 v[120:123], v223, s[88:89] offset:256 sc1
pp6_57:
    s_mov_b64 exec, -1
ppn_56:
    s_bitcmp1_b32 s63, 4
    s_cbranch_scc0 ppn_58
    s_cmp_eq_u32 s58, 0
    s_cbranch_scc1 ppn_58
    s_add_u32 s69, s40, s58
    s_lshl_b32 s70, s69, 14
    s_add_u32 s70, s70, 4194304
    v_add_u32 v223, s70, v220
    s_mov_b32 exec_lo, 0x000f000f
    s_mov_b32 exec_hi, 0x000f000f
    global_load_dwordx4 v[120:123], v223, s[88:89] sc1
    s_cmp_lg_u32 s32, 6
    s_cbranch_scc1 pp6_59
    global_load_dwordx4 v[120:123], v223, s[88:89] offset:256 sc1
pp6_59:
    s_mov_b64 exec, -1
ppn_58:
    s_bitcmp1_b32 s63, 5
    s_cbranch_scc0 ppn_60
    s_cmp_eq_u32 s59, 0
    s_cbranch_scc1 ppn_60
    s_add_u32 s69, s40, s59
    s_lshl_b32 s70, s69, 14
    s_add_u32 s70, s70, 4194304
    v_add_u32 v223, s70, v220
    s_mov_b32 exec_lo, 0x000f000f
    s_mov_b32 exec_hi, 0x000f000f
    global_load_dwordx4 v[120:123], v223, s[88:89] sc1
    s_cmp_lg_u32 s32, 6
    s_cbranch_scc1 pp6_61
    global_load_dwordx4 v[120:123], v223, s[88:89] offset:256 sc1
pp6_61:
    s_mov_b64 exec, -1
ppn_60:
    s_bitcmp1_b32 s63, 6
    s_cbranch_scc0 ppn_62
    s_cmp_eq_u32 s60, 0
    s_cbranch_scc1 ppn_62
    s_add_u32 s69, s40, s60
    s_lshl_b32 s70, s69, 14
    s_add_u32 s70, s70, 4194304
    v_add_u32 v223, s70, v220
    s_mov_b32 exec_lo, 0x000f000f
    s_mov_b32 exec_hi, 0x000f000f
    global_load_dwordx4 v[120:123], v223, s[88:89] sc1
    s_cmp_lg_u32 s32, 6
    s_cbranch_scc1 pp6_63
    global_load_dwordx4 v[120:123], v223, s[88:89] offset:256 sc1
pp6_63:
    s_mov_b64 exec, -1
ppn_62:
pp_49:
    s_cmp_lg_u32 s32, 0
    s_cbranch_scc1 ml_64
    v_and_b32 v25, 31, v1
    v_lshlrev_b32 v25, 2, v25
    v_add_u32 v25, 159744, v25
    ds_read_b32 v196, v25 offset:1024
    ds_read_b32 v204, v25 offset:3072
    ds_read_b32 v197, v25 offset:1152
    ds_read_b32 v205, v25 offset:3200
    ds_read_b32 v198, v25 offset:1280
    ds_read_b32 v206, v25 offset:3328
    ds_read_b32 v199, v25 offset:1408
    ds_read_b32 v207, v25 offset:3456
    ds_read_b32 v200, v25 offset:1536
    ds_read_b32 v208, v25 offset:3584
    ds_read_b32 v201, v25 offset:1664
    ds_read_b32 v209, v25 offset:3712
    ds_read_b32 v202, v25 offset:1792
    ds_read_b32 v210, v25 offset:3840
    v_mov_b32 v213, s67
    v_mov_b32 v215, s67
    s_waitcnt lgkmcnt(0)
    v_mov_b32 v26, 0
    s_bitcmp1_b32 s62, 6
    s_cbranch_scc0 mlk_66
    v_mov_b32 v26, 0
mlk_66:
    v_add_f32 v26, v26, v202
    s_bitcmp1_b32 s63, 6
    s_cbranch_scc0 mlf_65
    v_mov_b32 v212, v210
    v_mov_b32 v214, v26
    s_add_u32 s69, s40, s60
    s_lshl_b32 s70, s69, 9
    s_add_u32 s70, s70, 3145728
    s_cmp_lg_u32 s60, 0
    s_cbranch_scc1 mlp_67
    v_lshl_add_u32 v27, v1, 4, s70
    s_mov_b32 exec_hi, 0
    s_branch mls_68
mlp_67:
    s_sub_u32 s71, s60, 1
    s_and_b32 s71, s71, 3
    s_lshl_b32 s71, s71, 2
    s_lshl_b32 s71, 0xf, s71
    v_and_b32 v27, 3, v1
    v_lshl_add_u32 v27, v27, 4, s70
    s_mov_b32 exec_lo, s71
    s_mov_b32 exec_hi, 0
mls_68:
    v_add_u32 v28, 4194304, v27
    global_store_dwordx4 v28, v[212:215], s[88:89]
    global_store_dwordx4 v27, v[212:215], s[88:89] sc1
    s_mov_b64 exec, -1
    s_nop 1
mlf_65:
    s_bitcmp1_b32 s62, 5
    s_cbranch_scc0 mlk_70
    v_mov_b32 v26, 0
mlk_70:
    v_add_f32 v26, v26, v201
    s_bitcmp1_b32 s63, 5
    s_cbranch_scc0 mlf_69
    v_mov_b32 v212, v209
    v_mov_b32 v214, v26
    s_add_u32 s69, s40, s59
    s_lshl_b32 s70, s69, 9
    s_add_u32 s70, s70, 3145728
    s_cmp_lg_u32 s59, 0
    s_cbranch_scc1 mlp_71
    v_lshl_add_u32 v27, v1, 4, s70
    s_mov_b32 exec_hi, 0
    s_branch mls_72
mlp_71:
    s_sub_u32 s71, s59, 1
    s_and_b32 s71, s71, 3
    s_lshl_b32 s71, s71, 2
    s_lshl_b32 s71, 0xf, s71
    v_and_b32 v27, 3, v1
    v_lshl_add_u32 v27, v27, 4, s70
    s_mov_b32 exec_lo, s71
    s_mov_b32 exec_hi, 0
mls_72:
    v_add_u32 v28, 4194304, v27
    global_store_dwordx4 v28, v[212:215], s[88:89]
    global_store_dwordx4 v27, v[212:215], s[88:89] sc1
    s_mov_b64 exec, -1
    s_nop 1
mlf_69:
    s_bitcmp1_b32 s62, 4
    s_cbranch_scc0 mlk_74
    v_mov_b32 v26, 0
mlk_74:
    v_add_f32 v26, v26, v200
    s_bitcmp1_b32 s63, 4
    s_cbranch_scc0 mlf_73
    v_mov_b32 v212, v208
    v_mov_b32 v214, v26
    s_add_u32 s69, s40, s58
    s_lshl_b32 s70, s69, 9
    s_add_u32 s70, s70, 3145728
    s_cmp_lg_u32 s58, 0
    s_cbranch_scc1 mlp_75
    v_lshl_add_u32 v27, v1, 4, s70
    s_mov_b32 exec_hi, 0
    s_branch mls_76
mlp_75:
    s_sub_u32 s71, s58, 1
    s_and_b32 s71, s71, 3
    s_lshl_b32 s71, s71, 2
    s_lshl_b32 s71, 0xf, s71
    v_and_b32 v27, 3, v1
    v_lshl_add_u32 v27, v27, 4, s70
    s_mov_b32 exec_lo, s71
    s_mov_b32 exec_hi, 0
mls_76:
    v_add_u32 v28, 4194304, v27
    global_store_dwordx4 v28, v[212:215], s[88:89]
    global_store_dwordx4 v27, v[212:215], s[88:89] sc1
    s_mov_b64 exec, -1
    s_nop 1
mlf_73:
    s_bitcmp1_b32 s62, 3
    s_cbranch_scc0 mlk_78
    v_mov_b32 v26, 0
mlk_78:
    v_add_f32 v26, v26, v199
    s_bitcmp1_b32 s63, 3
    s_cbranch_scc0 mlf_77
    v_mov_b32 v212, v207
    v_mov_b32 v214, v26
    s_add_u32 s69, s40, s57
    s_lshl_b32 s70, s69, 9
    s_add_u32 s70, s70, 3145728
    s_cmp_lg_u32 s57, 0
    s_cbranch_scc1 mlp_79
    v_lshl_add_u32 v27, v1, 4, s70
    s_mov_b32 exec_hi, 0
    s_branch mls_80
mlp_79:
    s_sub_u32 s71, s57, 1
    s_and_b32 s71, s71, 3
    s_lshl_b32 s71, s71, 2
    s_lshl_b32 s71, 0xf, s71
    v_and_b32 v27, 3, v1
    v_lshl_add_u32 v27, v27, 4, s70
    s_mov_b32 exec_lo, s71
    s_mov_b32 exec_hi, 0
mls_80:
    v_add_u32 v28, 4194304, v27
    global_store_dwordx4 v28, v[212:215], s[88:89]
    global_store_dwordx4 v27, v[212:215], s[88:89] sc1
    s_mov_b64 exec, -1
    s_nop 1
mlf_77:
    s_bitcmp1_b32 s62, 2
    s_cbranch_scc0 mlk_82
    v_mov_b32 v26, 0
mlk_82:
    v_add_f32 v26, v26, v198
    s_bitcmp1_b32 s63, 2
    s_cbranch_scc0 mlf_81
    v_mov_b32 v212, v206
    v_mov_b32 v214, v26
    s_add_u32 s69, s40, s56
    s_lshl_b32 s70, s69, 9
    s_add_u32 s70, s70, 3145728
    s_cmp_lg_u32 s56, 0
    s_cbranch_scc1 mlp_83
    v_lshl_add_u32 v27, v1, 4, s70
    s_mov_b32 exec_hi, 0
    s_branch mls_84
mlp_83:
    s_sub_u32 s71, s56, 1
    s_and_b32 s71, s71, 3
    s_lshl_b32 s71, s71, 2
    s_lshl_b32 s71, 0xf, s71
    v_and_b32 v27, 3, v1
    v_lshl_add_u32 v27, v27, 4, s70
    s_mov_b32 exec_lo, s71
    s_mov_b32 exec_hi, 0
mls_84:
    v_add_u32 v28, 4194304, v27
    global_store_dwordx4 v28, v[212:215], s[88:89]
    global_store_dwordx4 v27, v[212:215], s[88:89] sc1
    s_mov_b64 exec, -1
    s_nop 1
mlf_81:
    s_bitcmp1_b32 s62, 1
    s_cbranch_scc0 mlk_86
    v_mov_b32 v26, 0
mlk_86:
    v_add_f32 v26, v26, v197
    s_bitcmp1_b32 s63, 1
    s_cbranch_scc0 mlf_85
    v_mov_b32 v212, v205
    v_mov_b32 v214, v26
    s_add_u32 s69, s40, s55
    s_lshl_b32 s70, s69, 9
    s_add_u32 s70, s70, 3145728
    s_cmp_lg_u32 s55, 0
    s_cbranch_scc1 mlp_87
    v_lshl_add_u32 v27, v1, 4, s70
    s_mov_b32 exec_hi, 0
    s_branch mls_88
mlp_87:
    s_sub_u32 s71, s55, 1
    s_and_b32 s71, s71, 3
    s_lshl_b32 s71, s71, 2
    s_lshl_b32 s71, 0xf, s71
    v_and_b32 v27, 3, v1
    v_lshl_add_u32 v27, v27, 4, s70
    s_mov_b32 exec_lo, s71
    s_mov_b32 exec_hi, 0
mls_88:
    v_add_u32 v28, 4194304, v27
    global_store_dwordx4 v28, v[212:215], s[88:89]
    global_store_dwordx4 v27, v[212:215], s[88:89] sc1
    s_mov_b64 exec, -1
    s_nop 1
mlf_85:
    s_bitcmp1_b32 s62, 0
    s_cbranch_scc0 mlk_90
    v_mov_b32 v26, 0
mlk_90:
    v_add_f32 v26, v26, v196
    s_bitcmp1_b32 s63, 0
    s_cbranch_scc0 mlf_89
    v_mov_b32 v212, v204
    v_mov_b32 v214, v26
    s_add_u32 s69, s40, s54
    s_lshl_b32 s70, s69, 9
    s_add_u32 s70, s70, 3145728
    s_cmp_lg_u32 s54, 0
    s_cbranch_scc1 mlp_91
    v_lshl_add_u32 v27, v1, 4, s70
    s_mov_b32 exec_hi, 0
    s_branch mls_92
mlp_91:
    s_sub_u32 s71, s54, 1
    s_and_b32 s71, s71, 3
    s_lshl_b32 s71, s71, 2
    s_lshl_b32 s71, 0xf, s71
    v_and_b32 v27, 3, v1
    v_lshl_add_u32 v27, v27, 4, s70
    s_mov_b32 exec_lo, s71
    s_mov_b32 exec_hi, 0
mls_92:
    v_add_u32 v28, 4194304, v27
    global_store_dwordx4 v28, v[212:215], s[88:89]
    global_store_dwordx4 v27, v[212:215], s[88:89] sc1
    s_mov_b64 exec, -1
    s_nop 1
mlf_89:
ml_64:
    s_cmp_lg_u32 s32, 7
    s_cbranch_scc1 w7_93
    s_waitcnt vmcnt(0)
w7_93:
    s_waitcnt lgkmcnt(0)
    s_barrier
    ds_read_b64_tr_b16 v[56:57], v17 offset:40960
    ds_read_b64_tr_b16 v[58:59], v17 offset:45056
    ds_read_b64_tr_b16 v[52:53], v17 offset:24576
    ds_read_b64_tr_b16 v[54:55], v17 offset:28672
    ds_read_b64_tr_b16 v[48:49], v17 offset:8192
    ds_read_b64_tr_b16 v[50:51], v17 offset:12288
    ds_read_b64_tr_b16 v[44:45], v16 offset:57344
    ds_read_b64_tr_b16 v[46:47], v16 offset:61440
    ds_read_b64_tr_b16 v[40:41], v16 offset:40960
    ds_read_b64_tr_b16 v[42:43], v16 offset:45056
    ds_read_b64_tr_b16 v[36:37], v16 offset:24576
    ds_read_b64_tr_b16 v[38:39], v16 offset:28672
    ds_read_b64_tr_b16 v[32:33], v16 offset:8192
    ds_read_b64_tr_b16 v[34:35], v16 offset:12288
    s_cmp_lg_u32 s61, 0x81
    s_cbranch_scc1 sbg_94
    s_waitcnt lgkmcnt(12)
    v_mfma_f32_16x16x32_bf16 v[176:179], v[56:59], v[112:115], v[176:179]
    s_waitcnt lgkmcnt(10)
    v_mfma_f32_16x16x32_bf16 v[168:171], v[52:55], v[104:107], v[176:179]
    s_waitcnt lgkmcnt(8)
    v_mfma_f32_16x16x32_bf16 v[160:163], v[48:51], v[96:99], v[168:171]
    s_waitcnt lgkmcnt(6)
    v_mfma_f32_16x16x32_bf16 v[152:155], v[44:47], v[88:91], v[160:163]
    s_waitcnt lgkmcnt(4)
    v_mfma_f32_16x16x32_bf16 v[144:147], v[40:43], v[80:83], v[152:155]
    s_waitcnt lgkmcnt(2)
    v_mfma_f32_16x16x32_bf16 v[136:139], v[36:39], v[72:75], v[144:147]
    s_waitcnt lgkmcnt(0)
    v_mfma_f32_16x16x32_bf16 v[128:131], v[32:35], v[64:67], v[136:139]
    s_branch sbf_95
sbg_94:
    s_waitcnt lgkmcnt(12)
    s_bitcmp1_b32 s62, 6
    s_cbranch_scc1 ra_96
ra_96:
    v_mfma_f32_16x16x32_bf16 v[176:179], v[56:59], v[112:115], v[176:179]
rb_97:
    s_waitcnt lgkmcnt(10)
    s_bitcmp1_b32 s62, 5
    s_cbranch_scc1 ra_98
    v_mfma_f32_16x16x32_bf16 v[168:171], v[52:55], v[104:107], v[176:179]
    s_branch rb_99
ra_98:
    v_mfma_f32_16x16x32_bf16 v[168:171], v[52:55], v[104:107], v[168:171]
rb_99:
    s_waitcnt lgkmcnt(8)
    s_bitcmp1_b32 s62, 4
    s_cbranch_scc1 ra_100
    v_mfma_f32_16x16x32_bf16 v[160:163], v[48:51], v[96:99], v[168:171]
    s_branch rb_101
ra_100:
    v_mfma_f32_16x16x32_bf16 v[160:163], v[48:51], v[96:99], v[160:163]
rb_101:
    s_waitcnt lgkmcnt(6)
    s_bitcmp1_b32 s62, 3
    s_cbranch_scc1 ra_102
    v_mfma_f32_16x16x32_bf16 v[152:155], v[44:47], v[88:91], v[160:163]
    s_branch rb_103
ra_102:
    v_mfma_f32_16x16x32_bf16 v[152:155], v[44:47], v[88:91], v[152:155]
rb_103:
    s_waitcnt lgkmcnt(4)
    s_bitcmp1_b32 s62, 2
    s_cbranch_scc1 ra_104
    v_mfma_f32_16x16x32_bf16 v[144:147], v[40:43], v[80:83], v[152:155]
    s_branch rb_105
ra_104:
    v_mfma_f32_16x16x32_bf16 v[144:147], v[40:43], v[80:83], v[144:147]
rb_105:
    s_waitcnt lgkmcnt(2)
    s_bitcmp1_b32 s62, 1
    s_cbranch_scc1 ra_106
    v_mfma_f32_16x16x32_bf16 v[136:139], v[36:39], v[72:75], v[144:147]
    s_branch rb_107
ra_106:
    v_mfma_f32_16x16x32_bf16 v[136:139], v[36:39], v[72:75], v[136:139]
rb_107:
    s_waitcnt lgkmcnt(0)
    s_bitcmp1_b32 s62, 0
    s_cbranch_scc1 ra_108
    v_mfma_f32_16x16x32_bf16 v[128:131], v[32:35], v[64:67], v[136:139]
    s_branch rb_109
ra_108:
    v_mfma_f32_16x16x32_bf16 v[128:131], v[32:35], v[64:67], v[128:131]
rb_109:
sbf_95:
    s_nop 7
    v_cvt_pk_bf16_f32 v224, v128, v129
    v_cvt_pk_bf16_f32 v226, v130, v131
    s_mov_b64 exec, s[94:95]
    global_store_dwordx4 v238, v[224:227], s[88:89]
    s_cmp_eq_u32 s73, 0
    s_cbranch_scc1 f0_111
    global_store_dwordx4 v240, v[224:227], s[88:89] sc1
f0_111:
    s_mov_b64 exec, -1
    s_and_b32 s73, s63, 0xfe
    s_cbranch_scc0 L_consume
xp_112:
    s_ff1_i32_b32 s68, s73
    s_bitset0_b32 s73, s68
    s_mov_b32 m0, s68
    s_lshl_b32 s72, s68, 3
    s_movrels_b32 s71, s54
    s_set_gpr_idx_on s72, gpr_idx(SRC0,SRC1)
    s_nop 0
    v_cvt_pk_bf16_f32 v224, v128, v129
    v_cvt_pk_bf16_f32 v226, v130, v131
    s_set_gpr_idx_off
    s_add_u32 s69, s40, s71
    s_lshl_b32 s70, s69, 14
    s_sub_u32 s71, s71, 1
    s_and_b32 s69, s71, 3
    v_add_u32 v222, s70, v220
    v_cmp_eq_u32 vcc, s69, v221
    v_add_u32 v223, 4194304, v222
    s_mov_b64 exec, vcc
    global_store_dwordx4 v223, v[224:227], s[88:89]
    s_bitcmp1_b32 s100, s71
    s_cbranch_scc1 xpb_113
    global_store_dwordx4 v222, v[224:227], s[88:89] sc1
xpb_113:
    s_mov_b64 exec, -1
    s_nop 1
    s_cmp_lg_u32 s73, 0
    s_cbranch_scc1 xp_112
L_consume:
    s_mov_b32 s72, s100
L_cgrp:
    s_cmp_eq_u32 s72, 0
    s_cbranch_scc1 L_round_end
    s_ff1_i32_b32 s97, s72
    s_bitset0_b32 s72, s97
    v_readlane_b32 s85, v29, s97
    v_readlane_b32 s86, v30, s97
    s_nop 0
    s_add_u32 s87, s84, s86
    v_mov_b32 v200, 0xff800000
    v_mov_b32 v201, 0
    v_mov_b32 v204, 0
    v_mov_b32 v205, 0
    v_mov_b32 v206, 0
    v_mov_b32 v207, 0
    s_mov_b32 s101, 0
    s_cmp_eq_u32 s91, 1
    s_cbranch_scc1 L_cpre
L_cchunk:
    v_lshrrev_b32 v250, 2, v1
    v_and_b32 v250, 3, v250
    v_and_b32 v219, 3, v1
    v_lshl_add_u32 v219, v2, 2, v219
    s_add_u32 s68, s85, s97
    s_add_u32 s68, s68, 1
    s_sub_u32 s68, s68, s84
    s_sub_u32 s69, s87, 1
    s_lshl_b32 s70, s32, 8
    s_add_u32 s70, s70, 4194304
    v_add_u32 v216, s101, v250
    v_add_u32 v216, 0, v216
    v_cmp_lt_u32 vcc, s69, v216
    v_min_u32 v216, s69, v216
    v_mov_b32 v218, s97
    v_cndmask_b32 v247, 0, 1, vcc
    v_cmp_gt_u32 vcc, s84, v216
    v_add_u32 v217, s68, v216
    s_nop 0
    v_cndmask_b32 v217, v217, v216, vcc
    v_cndmask_b32 v218, 0, v218, vcc
    v_lshlrev_b32 v232, 14, v217
    v_lshl_add_u32 v232, v218, 11, v232
    v_lshl_add_u32 v232, v219, 4, v232
    v_add_u32 v232, s70, v232
    v_lshlrev_b32 v235, 9, v217
    v_lshl_add_u32 v235, v218, 6, v235
    v_and_b32 v217, 3, v1
    v_lshl_add_u32 v235, v217, 4, v235
    v_add_u32 v235, 7340032, v235
    v_add_u32 v216, s101, v250
    v_add_u32 v216, 4, v216
    v_cmp_lt_u32 vcc, s69, v216
    v_min_u32 v216, s69, v216
    v_mov_b32 v218, s97
    v_cndmask_b32 v248, 0, 1, vcc
    v_cmp_gt_u32 vcc, s84, v216
    v_add_u32 v217, s68, v216
    s_nop 0
    v_cndmask_b32 v217, v217, v216, vcc
    v_cndmask_b32 v218, 0, v218, vcc
    v_lshlrev_b32 v233, 14, v217
    v_lshl_add_u32 v233, v218, 11, v233
    v_lshl_add_u32 v233, v219, 4, v233
    v_add_u32 v233, s70, v233
    v_lshlrev_b32 v236, 9, v217
    v_lshl_add_u32 v236, v218, 6, v236
    v_and_b32 v217, 3, v1
    v_lshl_add_u32 v236, v217, 4, v236
    v_add_u32 v236, 7340032, v236
    v_add_u32 v216, s101, v250
    v_add_u32 v216, 8, v216
    v_cmp_lt_u32 vcc, s69, v216
    v_min_u32 v216, s69, v216
    v_mov_b32 v218, s97
    v_cndmask_b32 v249, 0, 1, vcc
    v_cmp_gt_u32 vcc, s84, v216
    v_add_u32 v217, s68, v216
    s_nop 0
    v_cndmask_b32 v217, v217, v216, vcc
    v_cndmask_b32 v218, 0, v218, vcc
    v_lshlrev_b32 v234, 14, v217
    v_lshl_add_u32 v234, v218, 11, v234
    v_lshl_add_u32 v234, v219, 4, v234
    v_add_u32 v234, s70, v234
    v_lshlrev_b32 v237, 9, v217
    v_lshl_add_u32 v237, v218, 6, v237
    v_and_b32 v217, 3, v1
    v_lshl_add_u32 v237, v217, 4, v237
    v_add_u32 v237, 7340032, v237
L_cpre:
    s_add_u32 s68, s101, 0
    s_cmp_lt_u32 s68, s87
    s_cselect_b64 s[74:75], -1, 0
    v_mov_b32 v32, 0
    v_mov_b32 v34, 0
    v_mov_b32 v40, 0xff800000
    v_mov_b32 v42, 0
    s_add_u32 s68, s101, 4
    s_cmp_lt_u32 s68, s87
    s_cselect_b64 s[76:77], -1, 0
    v_mov_b32 v44, 0
    v_mov_b32 v46, 0
    v_mov_b32 v52, 0xff800000
    v_mov_b32 v54, 0
    s_add_u32 s68, s101, 8
    s_cmp_lt_u32 s68, s87
    s_cselect_b64 s[78:79], -1, 0
    v_mov_b32 v56, 0
    v_mov_b32 v58, 0
    v_mov_b32 v64, 0xff800000
    v_mov_b32 v66, 0
    s_mov_b32 s91, 0
L_cpoll:
    s_mov_b64 exec, s[74:75]
    s_cbranch_execz ck_201
    global_load_dwordx4 v[32:35], v232, s[88:89] sc1
    global_load_dwordx4 v[40:43], v235, s[88:89] sc1
ck_201:
    s_mov_b64 exec, s[76:77]
    s_cbranch_execz ck_202
    global_load_dwordx4 v[44:47], v233, s[88:89] sc1
    global_load_dwordx4 v[52:55], v236, s[88:89] sc1
ck_202:
    s_mov_b64 exec, s[78:79]
    s_cbranch_execz ck_203
    global_load_dwordx4 v[56:59], v234, s[88:89] sc1
    global_load_dwordx4 v[64:67], v237, s[88:89] sc1
ck_203:
    s_mov_b64 exec, -1
    s_waitcnt vmcnt(0)
    v_xor_b32 v194, s67, v33
    v_xor_b32 v195, s67, v35
    v_or_b32 v194, v194, v195
    v_xor_b32 v195, s67, v41
    v_or_b32 v194, v194, v195
    v_xor_b32 v195, s67, v43
    v_or_b32 v194, v194, v195
    v_cmp_ne_u32 vcc, 0, v194
    s_nop 1
    s_and_b64 s[74:75], s[74:75], vcc
    v_xor_b32 v194, s67, v45
    v_xor_b32 v195, s67, v47
    v_or_b32 v194, v194, v195
    v_xor_b32 v195, s67, v53
    v_or_b32 v194, v194, v195
    v_xor_b32 v195, s67, v55
    v_or_b32 v194, v194, v195
    v_cmp_ne_u32 vcc, 0, v194
    s_nop 1
    s_and_b64 s[76:77], s[76:77], vcc
    v_xor_b32 v194, s67, v57
    v_xor_b32 v195, s67, v59
    v_or_b32 v194, v194, v195
    v_xor_b32 v195, s67, v65
    v_or_b32 v194, v194, v195
    v_xor_b32 v195, s67, v67
    v_or_b32 v194, v194, v195
    v_cmp_ne_u32 vcc, 0, v194
    s_nop 1
    s_and_b64 s[78:79], s[78:79], vcc
    s_or_b64 vcc, s[74:75], s[76:77]
    s_or_b64 vcc, vcc, s[78:79]
    s_cbranch_vccz L_cgo
    s_add_u32 s91, s91, 1
    s_cmp_lg_u32 s91, 10
    s_cbranch_scc1 L_cnx
    v_subrev_u32 v232, 4194304, v232
    v_subrev_u32 v235, 4194304, v235
    v_subrev_u32 v233, 4194304, v233
    v_subrev_u32 v236, 4194304, v236
    v_subrev_u32 v234, 4194304, v234
    v_subrev_u32 v237, 4194304, v237
L_cnx:
    s_cmp_lt_u32 s91, 0x40000
    s_cbranch_scc1 L_cpoll
L_cgo:
    v_mov_b32 v195, 0xff800000
    v_cmp_ne_u32 vcc, 0, v247
    v_lshlrev_b32 v36, 16, v32
    v_and_b32 v37, 0xffff0000, v32
    v_cndmask_b32 v40, v40, v195, vcc
    v_lshlrev_b32 v38, 16, v34
    v_and_b32 v39, 0xffff0000, v34
    v_cmp_ne_u32 vcc, 0, v248
    v_lshlrev_b32 v48, 16, v44
    v_and_b32 v49, 0xffff0000, v44
    v_cndmask_b32 v52, v52, v195, vcc
    v_lshlrev_b32 v50, 16, v46
    v_and_b32 v51, 0xffff0000, v46
    v_cmp_ne_u32 vcc, 0, v249
    v_lshlrev_b32 v60, 16, v56
    v_and_b32 v61, 0xffff0000, v56
    v_cndmask_b32 v64, v64, v195, vcc
    v_lshlrev_b32 v62, 16, v58
    v_and_b32 v63, 0xffff0000, v58
    v_max3_f32 v194, v200, v40, v52
    v_max_f32 v194, v194, v64
    s_nop 1
    v_max_f32_dpp v194, v194, v194 row_ror:4 row_mask:0xf bank_mask:0xf
    s_nop 1
    v_max_f32_dpp v194, v194, v194 row_ror:8 row_mask:0xf bank_mask:0xf
    v_sub_f32 v195, v200, v194
    v_sub_f32 v41, v40, v194
    v_sub_f32 v53, v52, v194
    v_sub_f32 v65, v64, v194
    v_exp_f32 v195, v195
    v_exp_f32 v41, v41
    v_exp_f32 v53, v53
    v_exp_f32 v65, v65
    v_mov_b32 v200, v194
    v_mul_f32 v201, v201, v195
    v_mul_f32 v204, v204, v195
    v_mul_f32 v205, v205, v195
    v_mul_f32 v206, v206, v195
    v_mul_f32 v207, v207, v195
    v_fmac_f32 v201, v41, v42
    v_fmac_f32 v204, v41, v36
    v_fmac_f32 v205, v41, v37
    v_fmac_f32 v206, v41, v38
    v_fmac_f32 v207, v41, v39
    v_fmac_f32 v201, v53, v54
    v_fmac_f32 v204, v53, v48
    v_fmac_f32 v205, v53, v49
    v_fmac_f32 v206, v53, v50
    v_fmac_f32 v207, v53, v51
    v_fmac_f32 v201, v65, v66
    v_fmac_f32 v204, v65, v60
    v_fmac_f32 v205, v65, v61
    v_fmac_f32 v206, v65, v62
    v_fmac_f32 v207, v65, v63
    s_add_u32 s101, s101, 12
    s_cmp_lt_u32 s101, s87
    s_cbranch_scc1 L_cchunk
    s_nop 1
    v_add_f32_dpp v201, v201, v201 row_ror:4 row_mask:0xf bank_mask:0xf
    v_add_f32_dpp v204, v204, v204 row_ror:4 row_mask:0xf bank_mask:0xf
    v_add_f32_dpp v205, v205, v205 row_ror:4 row_mask:0xf bank_mask:0xf
    v_add_f32_dpp v206, v206, v206 row_ror:4 row_mask:0xf bank_mask:0xf
    v_add_f32_dpp v207, v207, v207 row_ror:4 row_mask:0xf bank_mask:0xf
    s_nop 1
    v_add_f32_dpp v201, v201, v201 row_ror:8 row_mask:0xf bank_mask:0xf
    v_add_f32_dpp v204, v204, v204 row_ror:8 row_mask:0xf bank_mask:0xf
    v_add_f32_dpp v205, v205, v205 row_ror:8 row_mask:0xf bank_mask:0xf
    v_add_f32_dpp v206, v206, v206 row_ror:8 row_mask:0xf bank_mask:0xf
    v_add_f32_dpp v207, v207, v207 row_ror:8 row_mask:0xf bank_mask:0xf
    v_rcp_f32 v195, v201
    s_lshl_b32 s68, s97, 13
    s_lshl_b32 s69, s3, 10
    s_add_u32 s68, s68, s69
    s_lshl_b32 s69, s32, 5
    s_add_u32 s68, s68, s69
    v_and_b32 v216, 3, v1
    v_lshlrev_b32 v216, 8, v216
    v_lshl_add_u32 v216, v2, 3, v216
    v_add_u32 v216, s68, v216
    v_mul_f32 v204, v204, v195
    v_mul_f32 v205, v205, v195
    v_mul_f32 v206, v206, v195
    v_mul_f32 v207, v207, v195
    v_cvt_pk_bf16_f32 v212, v204, v205
    v_cvt_pk_bf16_f32 v213, v206, v207
    v_cmp_eq_u32 vcc, 0, v250
    s_nop 1
    s_mov_b64 exec, vcc
    global_store_dwordx2 v216, v[212:213], s[14:15]
    s_mov_b64 exec, -1
    s_mov_b32 s91, 0
    s_branch L_cgrp
L_round_end:
    s_cmp_eq_u32 s38, 1
    s_cbranch_scc1 L_fin
    s_waitcnt vmcnt(0) lgkmcnt(0)
    s_barrier
    v_lshlrev_b32 v4, 4, v3
    v_lshl_add_u32 v4, v2, 11, v4
    v_add_u32 v5, 8192, v4
    v_add_u32 v6, 16384, v4
    v_add_u32 v7, 24576, v4
L_round_next:
    s_add_u32 s39, s39, 1
    s_cmp_lt_u32 s39, s38
    s_cbranch_scc1 L_round
L_fin:
    s_endpgm
L_qk2:
    s_waitcnt vmcnt(20)
    ds_write_b128 v192, v[128:131] offset:0
    ds_write_b128 v193, v[132:135] offset:1024
    ds_write_b128 v192, v[136:139] offset:2048
    ds_write_b128 v193, v[140:143] offset:3072
    ds_read_b128 v[64:67], v12
    ds_read_b128 v[68:71], v13
    ds_read_b128 v[72:75], v14
    ds_read_b128 v[76:79], v15
    s_waitcnt lgkmcnt(0)
    v_mfma_f32_16x16x32_bf16 v[96:99], v[64:67], v[32:35], 0
    v_mfma_f32_16x16x32_bf16 v[96:99], v[68:71], v[36:39], v[96:99]
    v_mfma_f32_16x16x32_bf16 v[96:99], v[72:75], v[40:43], v[96:99]
    v_mfma_f32_16x16x32_bf16 v[96:99], v[76:79], v[44:47], v[96:99]
    v_mfma_f32_16x16x32_bf16 v[112:115], v[64:67], v[48:51], 0
    v_mfma_f32_16x16x32_bf16 v[112:115], v[68:71], v[52:55], v[112:115]
    v_mfma_f32_16x16x32_bf16 v[112:115], v[72:75], v[56:59], v[112:115]
    v_mfma_f32_16x16x32_bf16 v[112:115], v[76:79], v[60:63], v[112:115]
    s_waitcnt vmcnt(16)
    ds_write_b128 v192, v[144:147] offset:0
    ds_write_b128 v193, v[148:151] offset:1024
    ds_write_b128 v192, v[152:155] offset:2048
    ds_write_b128 v193, v[156:159] offset:3072
    ds_read_b128 v[80:83], v12
    ds_read_b128 v[84:87], v13
    ds_read_b128 v[88:91], v14
    ds_read_b128 v[92:95], v15
    s_waitcnt lgkmcnt(0)
    v_mfma_f32_16x16x32_bf16 v[100:103], v[80:83], v[32:35], 0
    v_mfma_f32_16x16x32_bf16 v[100:103], v[84:87], v[36:39], v[100:103]
    v_mfma_f32_16x16x32_bf16 v[100:103], v[88:91], v[40:43], v[100:103]
    v_mfma_f32_16x16x32_bf16 v[100:103], v[92:95], v[44:47], v[100:103]
    v_mfma_f32_16x16x32_bf16 v[116:119], v[80:83], v[48:51], 0
    v_mfma_f32_16x16x32_bf16 v[116:119], v[84:87], v[52:55], v[116:119]
    v_mfma_f32_16x16x32_bf16 v[116:119], v[88:91], v[56:59], v[116:119]
    v_mfma_f32_16x16x32_bf16 v[116:119], v[92:95], v[60:63], v[116:119]
    s_waitcnt vmcnt(12)
    ds_write_b128 v192, v[160:163] offset:0
    ds_write_b128 v193, v[164:167] offset:1024
    ds_write_b128 v192, v[168:171] offset:2048
    ds_write_b128 v193, v[172:175] offset:3072
    ds_read_b128 v[64:67], v12
    ds_read_b128 v[68:71], v13
    ds_read_b128 v[72:75], v14
    ds_read_b128 v[76:79], v15
    s_waitcnt lgkmcnt(0)
    v_mfma_f32_16x16x32_bf16 v[104:107], v[64:67], v[32:35], 0
    v_mfma_f32_16x16x32_bf16 v[104:107], v[68:71], v[36:39], v[104:107]
    v_mfma_f32_16x16x32_bf16 v[104:107], v[72:75], v[40:43], v[104:107]
    v_mfma_f32_16x16x32_bf16 v[104:107], v[76:79], v[44:47], v[104:107]
    v_mfma_f32_16x16x32_bf16 v[120:123], v[64:67], v[48:51], 0
    v_mfma_f32_16x16x32_bf16 v[120:123], v[68:71], v[52:55], v[120:123]
    v_mfma_f32_16x16x32_bf16 v[120:123], v[72:75], v[56:59], v[120:123]
    v_mfma_f32_16x16x32_bf16 v[120:123], v[76:79], v[60:63], v[120:123]
    s_waitcnt vmcnt(8)
    ds_write_b128 v192, v[176:179] offset:0
    ds_write_b128 v193, v[180:183] offset:1024
    ds_write_b128 v192, v[184:187] offset:2048
    ds_write_b128 v193, v[188:191] offset:3072
    ds_read_b128 v[80:83], v12
    ds_read_b128 v[84:87], v13
    ds_read_b128 v[88:91], v14
    ds_read_b128 v[92:95], v15
    s_waitcnt lgkmcnt(0)
    v_mfma_f32_16x16x32_bf16 v[108:111], v[80:83], v[32:35], 0
    v_mfma_f32_16x16x32_bf16 v[108:111], v[84:87], v[36:39], v[108:111]
    v_mfma_f32_16x16x32_bf16 v[108:111], v[88:91], v[40:43], v[108:111]
    v_mfma_f32_16x16x32_bf16 v[108:111], v[92:95], v[44:47], v[108:111]
    v_mfma_f32_16x16x32_bf16 v[124:127], v[80:83], v[48:51], 0
    v_mfma_f32_16x16x32_bf16 v[124:127], v[84:87], v[52:55], v[124:127]
    v_mfma_f32_16x16x32_bf16 v[124:127], v[88:91], v[56:59], v[124:127]
    v_mfma_f32_16x16x32_bf16 v[124:127], v[92:95], v[60:63], v[124:127]
    s_nop 7
    v_mul_f32 v96, s66, v96
    v_mul_f32 v97, s66, v97
    v_mul_f32 v98, s66, v98
    v_mul_f32 v99, s66, v99
    v_mul_f32 v100, s66, v100
    v_mul_f32 v101, s66, v101
    v_mul_f32 v102, s66, v102
    v_mul_f32 v103, s66, v103
    v_mul_f32 v104, s66, v104
    v_mul_f32 v105, s66, v105
    v_mul_f32 v106, s66, v106
    v_mul_f32 v107, s66, v107
    v_mul_f32 v108, s66, v108
    v_mul_f32 v109, s66, v109
    v_mul_f32 v110, s66, v110
    v_mul_f32 v111, s66, v111
    v_mul_f32 v112, s66, v112
    v_mul_f32 v113, s66, v113
    v_mul_f32 v114, s66, v114
    v_mul_f32 v115, s66, v115
    v_mul_f32 v116, s66, v116
    v_mul_f32 v117, s66, v117
    v_mul_f32 v118, s66, v118
    v_mul_f32 v119, s66, v119
    v_mul_f32 v120, s66, v120
    v_mul_f32 v121, s66, v121
    v_mul_f32 v122, s66, v122
    v_mul_f32 v123, s66, v123
    v_mul_f32 v124, s66, v124
    v_mul_f32 v125, s66, v125
    v_mul_f32 v126, s66, v126
    v_mul_f32 v127, s66, v127
    s_add_u32 s69, s48, 64
    s_cmp_le_u32 s69, s47
    s_cbranch_scc1 nomask_17
    v_lshl_add_u32 v25, v2, 2, s48
    v_mov_b32 v26, 0xceabfb8f
    v_add_u32 v27, 0, v25
    v_cmp_gt_u32 vcc, s47, v27
    s_nop 1
    v_cndmask_b32 v96, v26, v96, vcc
    v_cndmask_b32 v112, v26, v112, vcc
    v_add_u32 v27, 1, v25
    v_cmp_gt_u32 vcc, s47, v27
    s_nop 1
    v_cndmask_b32 v97, v26, v97, vcc
    v_cndmask_b32 v113, v26, v113, vcc
    v_add_u32 v27, 2, v25
    v_cmp_gt_u32 vcc, s47, v27
    s_nop 1
    v_cndmask_b32 v98, v26, v98, vcc
    v_cndmask_b32 v114, v26, v114, vcc
    v_add_u32 v27, 3, v25
    v_cmp_gt_u32 vcc, s47, v27
    s_nop 1
    v_cndmask_b32 v99, v26, v99, vcc
    v_cndmask_b32 v115, v26, v115, vcc
    v_add_u32 v27, 16, v25
    v_cmp_gt_u32 vcc, s47, v27
    s_nop 1
    v_cndmask_b32 v100, v26, v100, vcc
    v_cndmask_b32 v116, v26, v116, vcc
    v_add_u32 v27, 17, v25
    v_cmp_gt_u32 vcc, s47, v27
    s_nop 1
    v_cndmask_b32 v101, v26, v101, vcc
    v_cndmask_b32 v117, v26, v117, vcc
    v_add_u32 v27, 18, v25
    v_cmp_gt_u32 vcc, s47, v27
    s_nop 1
    v_cndmask_b32 v102, v26, v102, vcc
    v_cndmask_b32 v118, v26, v118, vcc
    v_add_u32 v27, 19, v25
    v_cmp_gt_u32 vcc, s47, v27
    s_nop 1
    v_cndmask_b32 v103, v26, v103, vcc
    v_cndmask_b32 v119, v26, v119, vcc
    v_add_u32 v27, 32, v25
    v_cmp_gt_u32 vcc, s47, v27
    s_nop 1
    v_cndmask_b32 v104, v26, v104, vcc
    v_cndmask_b32 v120, v26, v120, vcc
    v_add_u32 v27, 33, v25
    v_cmp_gt_u32 vcc, s47, v27
    s_nop 1
    v_cndmask_b32 v105, v26, v105, vcc
    v_cndmask_b32 v121, v26, v121, vcc
    v_add_u32 v27, 34, v25
    v_cmp_gt_u32 vcc, s47, v27
    s_nop 1
    v_cndmask_b32 v106, v26, v106, vcc
    v_cndmask_b32 v122, v26, v122, vcc
    v_add_u32 v27, 35, v25
    v_cmp_gt_u32 vcc, s47, v27
    s_nop 1
    v_cndmask_b32 v107, v26, v107, vcc
    v_cndmask_b32 v123, v26, v123, vcc
    v_add_u32 v27, 48, v25
    v_cmp_gt_u32 vcc, s47, v27
    s_nop 1
    v_cndmask_b32 v108, v26, v108, vcc
    v_cndmask_b32 v124, v26, v124, vcc
    v_add_u32 v27, 49, v25
    v_cmp_gt_u32 vcc, s47, v27
    s_nop 1
    v_cndmask_b32 v109, v26, v109, vcc
    v_cndmask_b32 v125, v26, v125, vcc
    v_add_u32 v27, 50, v25
    v_cmp_gt_u32 vcc, s47, v27
    s_nop 1
    v_cndmask_b32 v110, v26, v110, vcc
    v_cndmask_b32 v126, v26, v126, vcc
    v_add_u32 v27, 51, v25
    v_cmp_gt_u32 vcc, s47, v27
    s_nop 1
    v_cndmask_b32 v111, v26, v111, vcc
    v_cndmask_b32 v127, v26, v127, vcc
nomask_17:
    v_max3_f32 v196, v96, v97, v98
    v_max3_f32 v196, v196, v99, v100
    v_max3_f32 v196, v196, v101, v102
    v_max3_f32 v196, v196, v103, v104
    v_max3_f32 v196, v196, v105, v106
    v_max3_f32 v196, v196, v107, v108
    v_max3_f32 v196, v196, v109, v110
    v_max_f32 v196, v196, v111
    v_max3_f32 v197, v112, v113, v114
    v_max3_f32 v197, v197, v115, v116
    v_max3_f32 v197, v197, v117, v118
    v_max3_f32 v197, v197, v119, v120
    v_max3_f32 v197, v197, v121, v122
    v_max3_f32 v197, v197, v123, v124
    v_max3_f32 v197, v197, v125, v126
    v_max_f32 v197, v197, v127
    v_mov_b32 v198, v196
    v_mov_b32 v199, v197
    s_nop 1
    v_permlane32_swap_b32 v198, v196
    v_permlane32_swap_b32 v199, v197
    s_nop 1
    v_max_f32 v196, v196, v198
    v_max_f32 v197, v197, v199
    v_mov_b32 v198, v196
    v_mov_b32 v199, v197
    s_nop 1
    v_permlane16_swap_b32 v198, v196
    v_permlane16_swap_b32 v199, v197
    s_nop 1
    v_max_f32 v196, v196, v198
    v_max_f32 v197, v197, v199
    s_lshl_b32 s69, s32, 7
    s_add_u32 s69, s69, 159744
    v_lshl_add_u32 v25, v3, 2, s69
    ds_write_b32 v25, v196 offset:0
    ds_write_b32 v25, v197 offset:64
    s_add_u32 s70, s39, 1
    s_lshl_b32 s69, s32, 2
    s_add_u32 s69, s69, 161856
    v_mov_b32 v26, s69
    v_mov_b32 v27, s70
    ds_write_b32 v26, v27
    v_and_b32 v26, 7, v1
    v_lshlrev_b32 v26, 2, v26
    v_add_u32 v26, 161856, v26
fp_18:
    ds_read_b32 v27, v26
    s_waitcnt lgkmcnt(0)
    v_cmp_ne_u32 vcc, s70, v27
    s_nop 1
    s_and_b32 s69, vcc_lo, s49
    s_cbranch_scc1 fp_18
    v_lshlrev_b32 v26, 2, v3
    v_add_u32 v26, 159744, v26
    ds_read_b32 v200, v26 offset:0
    ds_read_b32 v201, v26 offset:64
    ds_read_b32 v202, v26 offset:128
    ds_read_b32 v203, v26 offset:192
    ds_read_b32 v204, v26 offset:256
    ds_read_b32 v205, v26 offset:320
    ds_read_b32 v206, v26 offset:384
    ds_read_b32 v207, v26 offset:448
    ds_read_b32 v208, v26 offset:512
    ds_read_b32 v209, v26 offset:576
    ds_read_b32 v210, v26 offset:640
    ds_read_b32 v211, v26 offset:704
    ds_read_b32 v212, v26 offset:768
    ds_read_b32 v213, v26 offset:832
    s_waitcnt lgkmcnt(0)
    s_bitcmp1_b32 s49, 0
    s_cbranch_scc0 pm_19
    v_max_f32 v196, v196, v200
    v_max_f32 v197, v197, v201
pm_19:
    s_bitcmp1_b32 s49, 1
    s_cbranch_scc0 pm_20
    v_max_f32 v196, v196, v202
    v_max_f32 v197, v197, v203
pm_20:
    s_bitcmp1_b32 s49, 2
    s_cbranch_scc0 pm_21
    v_max_f32 v196, v196, v204
    v_max_f32 v197, v197, v205
pm_21:
    s_bitcmp1_b32 s49, 3
    s_cbranch_scc0 pm_22
    v_max_f32 v196, v196, v206
    v_max_f32 v197, v197, v207
pm_22:
    s_bitcmp1_b32 s49, 4
    s_cbranch_scc0 pm_23
    v_max_f32 v196, v196, v208
    v_max_f32 v197, v197, v209
pm_23:
    s_bitcmp1_b32 s49, 5
    s_cbranch_scc0 pm_24
    v_max_f32 v196, v196, v210
    v_max_f32 v197, v197, v211
pm_24:
    s_bitcmp1_b32 s49, 6
    s_cbranch_scc0 pm_25
    v_max_f32 v196, v196, v212
    v_max_f32 v197, v197, v213
pm_25:
    ds_write_b32 v25, v196 offset:3072
    ds_write_b32 v25, v197 offset:3136
    v_sub_f32 v96, v96, v196
    v_sub_f32 v97, v97, v196
    v_sub_f32 v98, v98, v196
    v_sub_f32 v99, v99, v196
    v_sub_f32 v100, v100, v196
    v_sub_f32 v101, v101, v196
    v_sub_f32 v102, v102, v196
    v_sub_f32 v103, v103, v196
    v_sub_f32 v104, v104, v196
    v_sub_f32 v105, v105, v196
    v_sub_f32 v106, v106, v196
    v_sub_f32 v107, v107, v196
    v_sub_f32 v108, v108, v196
    v_sub_f32 v109, v109, v196
    v_sub_f32 v110, v110, v196
    v_sub_f32 v111, v111, v196
    v_exp_f32 v96, v96
    v_exp_f32 v97, v97
    v_exp_f32 v98, v98
    v_exp_f32 v99, v99
    v_exp_f32 v100, v100
    v_exp_f32 v101, v101
    v_exp_f32 v102, v102
    v_exp_f32 v103, v103
    v_exp_f32 v104, v104
    v_exp_f32 v105, v105
    v_exp_f32 v106, v106
    v_exp_f32 v107, v107
    v_exp_f32 v108, v108
    v_exp_f32 v109, v109
    v_exp_f32 v110, v110
    v_exp_f32 v111, v111
    v_sub_f32 v112, v112, v197
    v_sub_f32 v113, v113, v197
    v_sub_f32 v114, v114, v197
    v_sub_f32 v115, v115, v197
    v_sub_f32 v116, v116, v197
    v_sub_f32 v117, v117, v197
    v_sub_f32 v118, v118, v197
    v_sub_f32 v119, v119, v197
    v_sub_f32 v120, v120, v197
    v_sub_f32 v121, v121, v197
    v_sub_f32 v122, v122, v197
    v_sub_f32 v123, v123, v197
    v_sub_f32 v124, v124, v197
    v_sub_f32 v125, v125, v197
    v_sub_f32 v126, v126, v197
    v_sub_f32 v127, v127, v197
    v_exp_f32 v112, v112
    v_exp_f32 v113, v113
    v_exp_f32 v114, v114
    v_exp_f32 v115, v115
    v_exp_f32 v116, v116
    v_exp_f32 v117, v117
    v_exp_f32 v118, v118
    v_exp_f32 v119, v119
    v_exp_f32 v120, v120
    v_exp_f32 v121, v121
    v_exp_f32 v122, v122
    v_exp_f32 v123, v123
    v_exp_f32 v124, v124
    v_exp_f32 v125, v125
    v_exp_f32 v126, v126
    v_exp_f32 v127, v127
    s_nop 0
    v_cvt_pk_bf16_f32 v64, v96, v97
    v_cvt_pk_bf16_f32 v65, v98, v99
    v_cvt_pk_bf16_f32 v66, v100, v101
    v_cvt_pk_bf16_f32 v67, v102, v103
    v_cvt_pk_bf16_f32 v68, v104, v105
    v_cvt_pk_bf16_f32 v69, v106, v107
    v_cvt_pk_bf16_f32 v70, v108, v109
    v_cvt_pk_bf16_f32 v71, v110, v111
    v_cvt_pk_bf16_f32 v72, v112, v113
    v_cvt_pk_bf16_f32 v73, v114, v115
    v_cvt_pk_bf16_f32 v74, v116, v117
    v_cvt_pk_bf16_f32 v75, v118, v119
    v_cvt_pk_bf16_f32 v76, v120, v121
    v_cvt_pk_bf16_f32 v77, v122, v123
    v_cvt_pk_bf16_f32 v78, v124, v125
    v_cvt_pk_bf16_f32 v79, v126, v127
    s_lshl_b32 s69, s32, 12
    v_add_u32 v26, s69, v18
    ds_write_b128 v26, v[64:67] offset:0
    ds_write_b128 v26, v[68:71] offset:2048
    ds_write_b128 v26, v[72:75] offset:1024
    ds_write_b128 v26, v[76:79] offset:3072
    v_add_f32 v200, v96, v97
    v_add_f32 v200, v200, v98
    v_add_f32 v200, v200, v99
    v_add_f32 v200, v200, v100
    v_add_f32 v200, v200, v101
    v_add_f32 v200, v200, v102
    v_add_f32 v200, v200, v103
    v_add_f32 v200, v200, v104
    v_add_f32 v200, v200, v105
    v_add_f32 v200, v200, v106
    v_add_f32 v200, v200, v107
    v_add_f32 v200, v200, v108
    v_add_f32 v200, v200, v109
    v_add_f32 v200, v200, v110
    v_add_f32 v200, v200, v111
    v_add_f32 v201, v112, v113
    v_add_f32 v201, v201, v114
    v_add_f32 v201, v201, v115
    v_add_f32 v201, v201, v116
    v_add_f32 v201, v201, v117
    v_add_f32 v201, v201, v118
    v_add_f32 v201, v201, v119
    v_add_f32 v201, v201, v120
    v_add_f32 v201, v201, v121
    v_add_f32 v201, v201, v122
    v_add_f32 v201, v201, v123
    v_add_f32 v201, v201, v124
    v_add_f32 v201, v201, v125
    v_add_f32 v201, v201, v126
    v_add_f32 v201, v201, v127
    v_mov_b32 v202, v200
    v_mov_b32 v203, v201
    s_nop 1
    v_permlane32_swap_b32 v202, v200
    v_permlane32_swap_b32 v203, v201
    s_nop 1
    v_add_f32 v200, v200, v202
    v_add_f32 v201, v201, v203
    v_mov_b32 v202, v200
    v_mov_b32 v203, v201
    s_nop 1
    v_permlane16_swap_b32 v202, v200
    v_permlane16_swap_b32 v203, v201
    s_nop 1
    v_add_f32 v200, v200, v202
    v_add_f32 v201, v201, v203
    ds_write_b32 v25, v200 offset:1024
    ds_write_b32 v25, v201 offset:1088
    s_waitcnt vmcnt(0) lgkmcnt(0)
    s_branch L_b2
L_service:
    v_lshrrev_b32 v196, 2, v1
    v_add_u32 v201, s41, v196
    v_mov_b32 v197, 0
    v_readlane_b32 s69, v23, 0
    s_nop 1
    v_cmp_le_u32 vcc, s69, v201
    s_nop 1
    v_addc_co_u32 v197, vcc, 0, v197, vcc
    v_readlane_b32 s69, v23, 1
    s_nop 1
    v_cmp_le_u32 vcc, s69, v201
    s_nop 1
    v_addc_co_u32 v197, vcc, 0, v197, vcc
    v_readlane_b32 s69, v23, 2
    s_nop 1
    v_cmp_le_u32 vcc, s69, v201
    s_nop 1
    v_addc_co_u32 v197, vcc, 0, v197, vcc
    v_readlane_b32 s69, v23, 3
    s_nop 1
    v_cmp_le_u32 vcc, s69, v201
    s_nop 1
    v_addc_co_u32 v197, vcc, 0, v197, vcc
    v_readlane_b32 s69, v23, 4
    s_nop 1
    v_cmp_le_u32 vcc, s69, v201
    s_nop 1
    v_addc_co_u32 v197, vcc, 0, v197, vcc
    v_readlane_b32 s69, v23, 5
    s_nop 1
    v_cmp_le_u32 vcc, s69, v201
    s_nop 1
    v_addc_co_u32 v197, vcc, 0, v197, vcc
    v_readlane_b32 s69, v23, 6
    s_nop 1
    v_cmp_le_u32 vcc, s69, v201
    s_nop 1
    v_addc_co_u32 v197, vcc, 0, v197, vcc
    v_readlane_b32 s69, v23, 7
    s_nop 1
    v_cmp_le_u32 vcc, s69, v201
    s_nop 1
    v_addc_co_u32 v197, vcc, 0, v197, vcc
    v_min_u32 v197, 7, v197
    v_lshlrev_b32 v200, 2, v197
    ds_bpermute_b32 v198, v200, v24
    ds_bpermute_b32 v199, v200, v20
    s_waitcnt lgkmcnt(0)
    v_sub_u32 v198, v201, v198
    v_lshlrev_b32 v198, 2, v198
    v_add_u32 v198, s34, v198
    v_cmp_gt_u32 vcc, s35, v201
    v_lshlrev_b32 v200, 2, v201
    v_mov_b32 v25, s34
    v_cndmask_b32 v198, v198, v200, vcc
    v_cndmask_b32 v199, v199, v25, vcc
    v_mov_b32 v25, 0
    v_cndmask_b32 v197, v197, v25, vcc
    v_and_b32 v25, 3, v1
    v_add_u32 v198, v198, v25
    v_cmp_lt_u32 s[74:75], v198, v199
    v_cmp_gt_u32 s[76:77], s42, v196
    v_min_u32 v198, 0xff, v198
    v_lshlrev_b32 v198, 2, v198
    v_lshl_add_u32 v198, v197, 10, v198
    v_add_u32 v198, 122880, v198
    ds_read_b32 v198, v198
    s_and_b64 vcc, s[74:75], s[76:77]
    s_lshl_b32 s68, s3, 8
    v_mov_b32 v27, 37748736
    s_waitcnt lgkmcnt(0)
    v_lshl_add_u32 v198, v198, 15, s68
    v_cndmask_b32 v242, v27, v198, vcc
    v_lshl_add_u32 v4, v2, 11, v31
    v_xor_b32 v5, 128, v4
    v_add_u32 v6, 14336, v4
    v_add_u32 v5, 7168, v5
    v_add_u32 v7, 14336, v5
    s_cmp_lg_u32 s39, 0
    s_cbranch_scc1 nn_26
    s_waitcnt vmcnt(0)
    v_cmp_eq_u32 vcc, 0, v246
    s_nop 1
    v_cndmask_b32 v246, v246, v244, vcc
    v_mov_b32 v26, 161920
    s_mov_b64 exec, 1
    ds_write_b32 v26, v246
    s_mov_b64 exec, -1
    s_waitcnt lgkmcnt(0)
nn_26:
    s_barrier
    v_readlane_b32 s50, v242, 2
    s_nop 3
    v_readlane_b32 s51, v242, 6
    s_mov_b32 m0, 8192
    s_nop 0
    buffer_load_dwordx4 v4, s[24:27], s50 offen offset:0 nt lds
    buffer_load_dwordx4 v5, s[24:27], s50 offen offset:1024 nt lds
    buffer_load_dwordx4 v6, s[24:27], s50 offen offset:2048 nt lds
    buffer_load_dwordx4 v7, s[24:27], s50 offen offset:3072 nt lds
    v_readlane_b32 s50, v242, 10
    s_mov_b32 m0, 24576
    s_nop 0
    buffer_load_dwordx4 v4, s[24:27], s51 offen offset:0 nt lds
    buffer_load_dwordx4 v5, s[24:27], s51 offen offset:1024 nt lds
    buffer_load_dwordx4 v6, s[24:27], s51 offen offset:2048 nt lds
    buffer_load_dwordx4 v7, s[24:27], s51 offen offset:3072 nt lds
    v_readlane_b32 s51, v242, 14
    s_mov_b32 m0, 40960
    s_nop 0
    buffer_load_dwordx4 v4, s[24:27], s50 offen offset:0 nt lds
    buffer_load_dwordx4 v5, s[24:27], s50 offen offset:1024 nt lds
    buffer_load_dwordx4 v6, s[24:27], s50 offen offset:2048 nt lds
    buffer_load_dwordx4 v7, s[24:27], s50 offen offset:3072 nt lds
    v_readlane_b32 s50, v242, 18
    s_mov_b32 m0, 57344
    s_nop 0
    buffer_load_dwordx4 v4, s[24:27], s51 offen offset:0 nt lds
    buffer_load_dwordx4 v5, s[24:27], s51 offen offset:1024 nt lds
    buffer_load_dwordx4 v6, s[24:27], s51 offen offset:2048 nt lds
    buffer_load_dwordx4 v7, s[24:27], s51 offen offset:3072 nt lds
    v_readlane_b32 s51, v242, 22
    s_mov_b32 m0, 73728
    s_nop 0
    buffer_load_dwordx4 v4, s[24:27], s50 offen offset:0 nt lds
    buffer_load_dwordx4 v5, s[24:27], s50 offen offset:1024 nt lds
    buffer_load_dwordx4 v6, s[24:27], s50 offen offset:2048 nt lds
    buffer_load_dwordx4 v7, s[24:27], s50 offen offset:3072 nt lds
    v_readlane_b32 s50, v242, 26
    s_mov_b32 m0, 90112
    s_nop 0
    buffer_load_dwordx4 v4, s[24:27], s51 offen offset:0 nt lds
    buffer_load_dwordx4 v5, s[24:27], s51 offen offset:1024 nt lds
    buffer_load_dwordx4 v6, s[24:27], s51 offen offset:2048 nt lds
    buffer_load_dwordx4 v7, s[24:27], s51 offen offset:3072 nt lds
    v_readlane_b32 s51, v242, 3
    s_mov_b32 m0, 106496
    s_nop 0
    buffer_load_dwordx4 v4, s[24:27], s50 offen offset:0 nt lds
    buffer_load_dwordx4 v5, s[24:27], s50 offen offset:1024 nt lds
    buffer_load_dwordx4 v6, s[24:27], s50 offen offset:2048 nt lds
    buffer_load_dwordx4 v7, s[24:27], s50 offen offset:3072 nt lds
    v_readlane_b32 s50, v242, 7
    s_mov_b32 m0, 12288
    s_nop 0
    buffer_load_dwordx4 v4, s[24:27], s51 offen offset:0 nt lds
    buffer_load_dwordx4 v5, s[24:27], s51 offen offset:1024 nt lds
    buffer_load_dwordx4 v6, s[24:27], s51 offen offset:2048 nt lds
    buffer_load_dwordx4 v7, s[24:27], s51 offen offset:3072 nt lds
    v_readlane_b32 s51, v242, 11
    s_mov_b32 m0, 28672
    s_nop 0
    buffer_load_dwordx4 v4, s[24:27], s50 offen offset:0 nt lds
    buffer_load_dwordx4 v5, s[24:27], s50 offen offset:1024 nt lds
    buffer_load_dwordx4 v6, s[24:27], s50 offen offset:2048 nt lds
    buffer_load_dwordx4 v7, s[24:27], s50 offen offset:3072 nt lds
    v_readlane_b32 s50, v242, 15
    s_mov_b32 m0, 45056
    s_nop 0
    buffer_load_dwordx4 v4, s[24:27], s51 offen offset:0 nt lds
    buffer_load_dwordx4 v5, s[24:27], s51 offen offset:1024 nt lds
    buffer_load_dwordx4 v6, s[24:27], s51 offen offset:2048 nt lds
    buffer_load_dwordx4 v7, s[24:27], s51 offen offset:3072 nt lds
    v_readlane_b32 s51, v242, 19
    s_mov_b32 m0, 61440
    s_nop 0
    buffer_load_dwordx4 v4, s[24:27], s50 offen offset:0 nt lds
    buffer_load_dwordx4 v5, s[24:27], s50 offen offset:1024 nt lds
    buffer_load_dwordx4 v6, s[24:27], s50 offen offset:2048 nt lds
    buffer_load_dwordx4 v7, s[24:27], s50 offen offset:3072 nt lds
    v_readlane_b32 s50, v242, 23
    s_mov_b32 m0, 77824
    s_nop 0
    buffer_load_dwordx4 v4, s[24:27], s51 offen offset:0 nt lds
    buffer_load_dwordx4 v5, s[24:27], s51 offen offset:1024 nt lds
    buffer_load_dwordx4 v6, s[24:27], s51 offen offset:2048 nt lds
    buffer_load_dwordx4 v7, s[24:27], s51 offen offset:3072 nt lds
    v_readlane_b32 s51, v242, 27
    s_mov_b32 m0, 94208
    s_nop 0
    buffer_load_dwordx4 v4, s[24:27], s50 offen offset:0 nt lds
    buffer_load_dwordx4 v5, s[24:27], s50 offen offset:1024 nt lds
    buffer_load_dwordx4 v6, s[24:27], s50 offen offset:2048 nt lds
    buffer_load_dwordx4 v7, s[24:27], s50 offen offset:3072 nt lds
    s_mov_b32 m0, 110592
    s_nop 0
    buffer_load_dwordx4 v4, s[24:27], s51 offen offset:0 nt lds
    buffer_load_dwordx4 v5, s[24:27], s51 offen offset:1024 nt lds
    buffer_load_dwordx4 v6, s[24:27], s51 offen offset:2048 nt lds
    buffer_load_dwordx4 v7, s[24:27], s51 offen offset:3072 nt lds
    s_branch L_b2
L_pv2:
    ds_read_b128 v[64:67], v18 offset:0
    ds_read_b128 v[68:71], v18 offset:1024
    ds_read_b128 v[72:75], v18 offset:4096
    ds_read_b128 v[76:79], v18 offset:5120
    ds_read_b128 v[80:83], v18 offset:8192
    ds_read_b128 v[84:87], v18 offset:9216
    ds_read_b128 v[88:91], v18 offset:12288
    ds_read_b128 v[92:95], v18 offset:13312
    ds_read_b128 v[96:99], v18 offset:16384
    ds_read_b128 v[100:103], v18 offset:17408
    ds_read_b128 v[104:107], v18 offset:20480
    ds_read_b128 v[108:111], v18 offset:21504
    ds_read_b128 v[112:115], v18 offset:24576
    ds_read_b128 v[116:119], v18 offset:25600
    ds_read_b64_tr_b16 v[32:33], v16 offset:0
    ds_read_b64_tr_b16 v[34:35], v16 offset:4096
    ds_read_b64_tr_b16 v[36:37], v16 offset:16384
    ds_read_b64_tr_b16 v[38:39], v16 offset:20480
    ds_read_b64_tr_b16 v[40:41], v16 offset:32768
    ds_read_b64_tr_b16 v[42:43], v16 offset:36864
    ds_read_b64_tr_b16 v[44:45], v16 offset:49152
    ds_read_b64_tr_b16 v[46:47], v16 offset:53248
    ds_read_b64_tr_b16 v[48:49], v17 offset:0
    ds_read_b64_tr_b16 v[50:51], v17 offset:4096
    ds_read_b64_tr_b16 v[52:53], v17 offset:16384
    ds_read_b64_tr_b16 v[54:55], v17 offset:20480
    ds_read_b64_tr_b16 v[56:57], v17 offset:32768
    ds_read_b64_tr_b16 v[58:59], v17 offset:36864
    s_waitcnt lgkmcnt(0)
    v_readfirstlane_b32 s67, v26
    s_bitcmp1_b32 s61, 0
    s_cbranch_scc1 fa_114
fa_114:
    v_mfma_f32_16x16x32_bf16 v[128:131], v[32:35], v[64:67], 0
    v_mfma_f32_16x16x32_bf16 v[132:135], v[32:35], v[68:71], 0
fb_115:
    s_bitcmp1_b32 s61, 1
    s_cbranch_scc1 fa_116
    v_mfma_f32_16x16x32_bf16 v[136:139], v[36:39], v[72:75], v[128:131]
    v_mfma_f32_16x16x32_bf16 v[140:143], v[36:39], v[76:79], v[132:135]
    s_branch fb_117
fa_116:
    v_mfma_f32_16x16x32_bf16 v[136:139], v[36:39], v[72:75], 0
    v_mfma_f32_16x16x32_bf16 v[140:143], v[36:39], v[76:79], 0
fb_117:
    s_bitcmp1_b32 s61, 2
    s_cbranch_scc1 fa_118
    v_mfma_f32_16x16x32_bf16 v[144:147], v[40:43], v[80:83], v[136:139]
    v_mfma_f32_16x16x32_bf16 v[148:151], v[40:43], v[84:87], v[140:143]
    s_branch fb_119
fa_118:
    v_mfma_f32_16x16x32_bf16 v[144:147], v[40:43], v[80:83], 0
    v_mfma_f32_16x16x32_bf16 v[148:151], v[40:43], v[84:87], 0
fb_119:
    s_bitcmp1_b32 s61, 3
    s_cbranch_scc1 fa_120
    v_mfma_f32_16x16x32_bf16 v[152:155], v[44:47], v[88:91], v[144:147]
    v_mfma_f32_16x16x32_bf16 v[156:159], v[44:47], v[92:95], v[148:151]
    s_branch fb_121
fa_120:
    v_mfma_f32_16x16x32_bf16 v[152:155], v[44:47], v[88:91], 0
    v_mfma_f32_16x16x32_bf16 v[156:159], v[44:47], v[92:95], 0
fb_121:
    s_bitcmp1_b32 s61, 4
    s_cbranch_scc1 fa_122
    v_mfma_f32_16x16x32_bf16 v[160:163], v[48:51], v[96:99], v[152:155]
    v_mfma_f32_16x16x32_bf16 v[164:167], v[48:51], v[100:103], v[156:159]
    s_branch fb_123
fa_122:
    v_mfma_f32_16x16x32_bf16 v[160:163], v[48:51], v[96:99], 0
    v_mfma_f32_16x16x32_bf16 v[164:167], v[48:51], v[100:103], 0
fb_123:
    s_bitcmp1_b32 s61, 5
    s_cbranch_scc1 fa_124
    v_mfma_f32_16x16x32_bf16 v[168:171], v[52:55], v[104:107], v[160:163]
    v_mfma_f32_16x16x32_bf16 v[172:175], v[52:55], v[108:111], v[164:167]
    s_branch fb_125
fa_124:
    v_mfma_f32_16x16x32_bf16 v[168:171], v[52:55], v[104:107], 0
    v_mfma_f32_16x16x32_bf16 v[172:175], v[52:55], v[108:111], 0
fb_125:
    s_bitcmp1_b32 s61, 6
    s_cbranch_scc1 fa_126
    v_mfma_f32_16x16x32_bf16 v[176:179], v[56:59], v[112:115], v[168:171]
    v_mfma_f32_16x16x32_bf16 v[180:183], v[56:59], v[116:119], v[172:175]
    s_branch fb_127
fa_126:
    v_mfma_f32_16x16x32_bf16 v[176:179], v[56:59], v[112:115], 0
    v_mfma_f32_16x16x32_bf16 v[180:183], v[56:59], v[116:119], 0
fb_127:
    ds_read_b128 v[64:67], v18 offset:2048
    ds_read_b128 v[68:71], v18 offset:3072
    ds_read_b128 v[72:75], v18 offset:6144
    ds_read_b128 v[76:79], v18 offset:7168
    ds_read_b128 v[80:83], v18 offset:10240
    ds_read_b128 v[84:87], v18 offset:11264
    ds_read_b128 v[88:91], v18 offset:14336
    ds_read_b128 v[92:95], v18 offset:15360
    ds_read_b128 v[96:99], v18 offset:18432
    ds_read_b128 v[100:103], v18 offset:19456
    ds_read_b128 v[104:107], v18 offset:22528
    ds_read_b128 v[108:111], v18 offset:23552
    ds_read_b128 v[112:115], v18 offset:26624
    ds_read_b128 v[116:119], v18 offset:27648
    s_mov_b32 s91, 0
    s_cmp_eq_u32 s100, 0
    s_cbranch_scc1 pt_128
    s_ff1_i32_b32 s97, s100
    v_readlane_b32 s85, v29, s97
    v_readlane_b32 s86, v30, s97
    s_nop 0
    s_add_u32 s87, s84, s86
    s_mov_b32 s101, 0
    v_lshrrev_b32 v250, 2, v1
    v_and_b32 v250, 3, v250
    v_and_b32 v219, 3, v1
    v_lshl_add_u32 v219, v2, 2, v219
    s_add_u32 s68, s85, s97
    s_add_u32 s68, s68, 1
    s_sub_u32 s68, s68, s84
    s_sub_u32 s69, s87, 1
    s_lshl_b32 s70, s32, 8
    s_add_u32 s70, s70, 4194304
    v_add_u32 v216, s101, v250
    v_add_u32 v216, 0, v216
    v_cmp_lt_u32 vcc, s69, v216
    v_min_u32 v216, s69, v216
    v_mov_b32 v218, s97
    v_cndmask_b32 v247, 0, 1, vcc
    v_cmp_gt_u32 vcc, s84, v216
    v_add_u32 v217, s68, v216
    s_nop 0
    v_cndmask_b32 v217, v217, v216, vcc
    v_cndmask_b32 v218, 0, v218, vcc
    v_lshlrev_b32 v232, 14, v217
    v_lshl_add_u32 v232, v218, 11, v232
    v_lshl_add_u32 v232, v219, 4, v232
    v_add_u32 v232, s70, v232
    v_lshlrev_b32 v235, 9, v217
    v_lshl_add_u32 v235, v218, 6, v235
    v_and_b32 v217, 3, v1
    v_lshl_add_u32 v235, v217, 4, v235
    v_add_u32 v235, 7340032, v235
    v_add_u32 v216, s101, v250
    v_add_u32 v216, 4, v216
    v_cmp_lt_u32 vcc, s69, v216
    v_min_u32 v216, s69, v216
    v_mov_b32 v218, s97
    v_cndmask_b32 v248, 0, 1, vcc
    v_cmp_gt_u32 vcc, s84, v216
    v_add_u32 v217, s68, v216
    s_nop 0
    v_cndmask_b32 v217, v217, v216, vcc
    v_cndmask_b32 v218, 0, v218, vcc
    v_lshlrev_b32 v233, 14, v217
    v_lshl_add_u32 v233, v218, 11, v233
    v_lshl_add_u32 v233, v219, 4, v233
    v_add_u32 v233, s70, v233
    v_lshlrev_b32 v236, 9, v217
    v_lshl_add_u32 v236, v218, 6, v236
    v_and_b32 v217, 3, v1
    v_lshl_add_u32 v236, v217, 4, v236
    v_add_u32 v236, 7340032, v236
    v_add_u32 v216, s101, v250
    v_add_u32 v216, 8, v216
    v_cmp_lt_u32 vcc, s69, v216
    v_min_u32 v216, s69, v216
    v_mov_b32 v218, s97
    v_cndmask_b32 v249, 0, 1, vcc
    v_cmp_gt_u32 vcc, s84, v216
    v_add_u32 v217, s68, v216
    s_nop 0
    v_cndmask_b32 v217, v217, v216, vcc
    v_cndmask_b32 v218, 0, v218, vcc
    v_lshlrev_b32 v234, 14, v217
    v_lshl_add_u32 v234, v218, 11, v234
    v_lshl_add_u32 v234, v219, 4, v234
    v_add_u32 v234, s70, v234
    v_lshlrev_b32 v237, 9, v217
    v_lshl_add_u32 v237, v218, 6, v237
    v_and_b32 v217, 3, v1
    v_lshl_add_u32 v237, v217, 4, v237
    v_add_u32 v237, 7340032, v237
    s_mov_b32 s91, 1
    s_cmp_eq_u32 s32, 7
    s_cbranch_scc1 pt_128
    v_add_u32 v216, 0, v250
    v_cmp_gt_u32 vcc, s84, v216
    s_nop 1
    s_mov_b64 exec, vcc
    s_cbranch_execz ptk_131
    global_load_dwordx4 v[120:123], v232, s[88:89] sc1
    s_cmp_lg_u32 s32, 6
    s_cbranch_scc1 ptk_131
    global_load_dwordx4 v[120:123], v232, s[88:89] offset:256 sc1
ptk_131:
    s_mov_b64 exec, -1
    v_add_u32 v216, 4, v250
    v_cmp_gt_u32 vcc, s84, v216
    s_nop 1
    s_mov_b64 exec, vcc
    s_cbranch_execz ptk_132
    global_load_dwordx4 v[120:123], v233, s[88:89] sc1
    s_cmp_lg_u32 s32, 6
    s_cbranch_scc1 ptk_132
    global_load_dwordx4 v[120:123], v233, s[88:89] offset:256 sc1
ptk_132:
    s_mov_b64 exec, -1
    v_add_u32 v216, 8, v250
    v_cmp_gt_u32 vcc, s84, v216
    s_nop 1
    s_mov_b64 exec, vcc
    s_cbranch_execz ptk_133
    global_load_dwordx4 v[120:123], v234, s[88:89] sc1
    s_cmp_lg_u32 s32, 6
    s_cbranch_scc1 ptk_133
    global_load_dwordx4 v[120:123], v234, s[88:89] offset:256 sc1
ptk_133:
    s_mov_b64 exec, -1
    s_cmp_lg_u32 s32, 0
    s_cbranch_scc1 pt_128
    global_load_dwordx4 v[120:123], v235, s[88:89] sc1
    global_load_dwordx4 v[120:123], v236, s[88:89] sc1
    global_load_dwordx4 v[120:123], v237, s[88:89] sc1
pt_128:
    s_lshl_b32 s68, s32, 8
    v_and_b32 v220, 3, v3
    v_lshl_add_u32 v220, v2, 2, v220
    v_lshlrev_b32 v220, 4, v220
    v_add_u32 v220, s68, v220
    v_lshrrev_b32 v221, 2, v3
    v_mov_b32 v225, s67
    v_mov_b32 v227, s67
    v_mov_b32 v229, s67
    v_mov_b32 v231, s67
    s_add_u32 s69, s40, s54
    s_lshl_b32 s70, s69, 14
    s_cmp_lg_u32 s54, 0
    s_cbranch_scc1 p0_134
    v_lshl_add_u32 v240, v221, 11, v220
    v_add_u32 v240, s70, v240
    s_mov_b64 s[94:95], -1
    s_mov_b32 s73, 1
    s_branch p1_135
p0_134:
    s_sub_u32 s71, s54, 1
    s_and_b32 s69, s71, 3
    v_add_u32 v240, s70, v220
    v_cmp_eq_u32 s[94:95], s69, v221
    s_bitcmp1_b32 s100, s71
    s_cselect_b32 s73, 0, 1
p1_135:
    v_add_u32 v238, 4194304, v240
    v_add_u32 v241, 0x2000, v240
    v_add_u32 v239, 0x2000, v238
    s_cmp_eq_u32 s32, 7
    s_cbranch_scc1 pp_136
    s_bitcmp1_b32 s63, 0
    s_cbranch_scc0 ppn_137
    s_cmp_eq_u32 s54, 0
    s_cbranch_scc1 ppn_137
    s_add_u32 s69, s40, s54
    s_lshl_b32 s70, s69, 14
    s_add_u32 s70, s70, 4194304
    v_add_u32 v223, s70, v220
    s_mov_b32 exec_lo, 0x000f000f
    s_mov_b32 exec_hi, 0x000f000f
    global_load_dwordx4 v[120:123], v223, s[88:89] sc1
    s_cmp_lg_u32 s32, 6
    s_cbranch_scc1 pp6_138
    global_load_dwordx4 v[120:123], v223, s[88:89] offset:256 sc1
pp6_138:
    s_mov_b64 exec, -1
ppn_137:
    s_bitcmp1_b32 s63, 1
    s_cbranch_scc0 ppn_139
    s_cmp_eq_u32 s55, 0
    s_cbranch_scc1 ppn_139
    s_add_u32 s69, s40, s55
    s_lshl_b32 s70, s69, 14
    s_add_u32 s70, s70, 4194304
    v_add_u32 v223, s70, v220
    s_mov_b32 exec_lo, 0x000f000f
    s_mov_b32 exec_hi, 0x000f000f
    global_load_dwordx4 v[120:123], v223, s[88:89] sc1
    s_cmp_lg_u32 s32, 6
    s_cbranch_scc1 pp6_140
    global_load_dwordx4 v[120:123], v223, s[88:89] offset:256 sc1
pp6_140:
    s_mov_b64 exec, -1
ppn_139:
    s_bitcmp1_b32 s63, 2
    s_cbranch_scc0 ppn_141
    s_cmp_eq_u32 s56, 0
    s_cbranch_scc1 ppn_141
    s_add_u32 s69, s40, s56
    s_lshl_b32 s70, s69, 14
    s_add_u32 s70, s70, 4194304
    v_add_u32 v223, s70, v220
    s_mov_b32 exec_lo, 0x000f000f
    s_mov_b32 exec_hi, 0x000f000f
    global_load_dwordx4 v[120:123], v223, s[88:89] sc1
    s_cmp_lg_u32 s32, 6
    s_cbranch_scc1 pp6_142
    global_load_dwordx4 v[120:123], v223, s[88:89] offset:256 sc1
pp6_142:
    s_mov_b64 exec, -1
ppn_141:
    s_bitcmp1_b32 s63, 3
    s_cbranch_scc0 ppn_143
    s_cmp_eq_u32 s57, 0
    s_cbranch_scc1 ppn_143
    s_add_u32 s69, s40, s57
    s_lshl_b32 s70, s69, 14
    s_add_u32 s70, s70, 4194304
    v_add_u32 v223, s70, v220
    s_mov_b32 exec_lo, 0x000f000f
    s_mov_b32 exec_hi, 0x000f000f
    global_load_dwordx4 v[120:123], v223, s[88:89] sc1
    s_cmp_lg_u32 s32, 6
    s_cbranch_scc1 pp6_144
    global_load_dwordx4 v[120:123], v223, s[88:89] offset:256 sc1
pp6_144:
    s_mov_b64 exec, -1
ppn_143:
    s_bitcmp1_b32 s63, 4
    s_cbranch_scc0 ppn_145
    s_cmp_eq_u32 s58, 0
    s_cbranch_scc1 ppn_145
    s_add_u32 s69, s40, s58
    s_lshl_b32 s70, s69, 14
    s_add_u32 s70, s70, 4194304
    v_add_u32 v223, s70, v220
    s_mov_b32 exec_lo, 0x000f000f
    s_mov_b32 exec_hi, 0x000f000f
    global_load_dwordx4 v[120:123], v223, s[88:89] sc1
    s_cmp_lg_u32 s32, 6
    s_cbranch_scc1 pp6_146
    global_load_dwordx4 v[120:123], v223, s[88:89] offset:256 sc1
pp6_146:
    s_mov_b64 exec, -1
ppn_145:
    s_bitcmp1_b32 s63, 5
    s_cbranch_scc0 ppn_147
    s_cmp_eq_u32 s59, 0
    s_cbranch_scc1 ppn_147
    s_add_u32 s69, s40, s59
    s_lshl_b32 s70, s69, 14
    s_add_u32 s70, s70, 4194304
    v_add_u32 v223, s70, v220
    s_mov_b32 exec_lo, 0x000f000f
    s_mov_b32 exec_hi, 0x000f000f
    global_load_dwordx4 v[120:123], v223, s[88:89] sc1
    s_cmp_lg_u32 s32, 6
    s_cbranch_scc1 pp6_148
    global_load_dwordx4 v[120:123], v223, s[88:89] offset:256 sc1
pp6_148:
    s_mov_b64 exec, -1
ppn_147:
    s_bitcmp1_b32 s63, 6
    s_cbranch_scc0 ppn_149
    s_cmp_eq_u32 s60, 0
    s_cbranch_scc1 ppn_149
    s_add_u32 s69, s40, s60
    s_lshl_b32 s70, s69, 14
    s_add_u32 s70, s70, 4194304
    v_add_u32 v223, s70, v220
    s_mov_b32 exec_lo, 0x000f000f
    s_mov_b32 exec_hi, 0x000f000f
    global_load_dwordx4 v[120:123], v223, s[88:89] sc1
    s_cmp_lg_u32 s32, 6
    s_cbranch_scc1 pp6_150
    global_load_dwordx4 v[120:123], v223, s[88:89] offset:256 sc1
pp6_150:
    s_mov_b64 exec, -1
ppn_149:
pp_136:
    s_cmp_lg_u32 s32, 0
    s_cbranch_scc1 ml_151
    v_and_b32 v25, 31, v1
    v_lshlrev_b32 v25, 2, v25
    v_add_u32 v25, 159744, v25
    ds_read_b32 v196, v25 offset:1024
    ds_read_b32 v204, v25 offset:3072
    ds_read_b32 v197, v25 offset:1152
    ds_read_b32 v205, v25 offset:3200
    ds_read_b32 v198, v25 offset:1280
    ds_read_b32 v206, v25 offset:3328
    ds_read_b32 v199, v25 offset:1408
    ds_read_b32 v207, v25 offset:3456
    ds_read_b32 v200, v25 offset:1536
    ds_read_b32 v208, v25 offset:3584
    ds_read_b32 v201, v25 offset:1664
    ds_read_b32 v209, v25 offset:3712
    ds_read_b32 v202, v25 offset:1792
    ds_read_b32 v210, v25 offset:3840
    v_mov_b32 v213, s67
    v_mov_b32 v215, s67
    s_waitcnt lgkmcnt(0)
    v_mov_b32 v26, 0
    s_bitcmp1_b32 s62, 6
    s_cbranch_scc0 mlk_153
    v_mov_b32 v26, 0
mlk_153:
    v_add_f32 v26, v26, v202
    s_bitcmp1_b32 s63, 6
    s_cbranch_scc0 mlf_152
    v_mov_b32 v212, v210
    v_mov_b32 v214, v26
    s_add_u32 s69, s40, s60
    s_lshl_b32 s70, s69, 9
    s_add_u32 s70, s70, 3145728
    s_cmp_lg_u32 s60, 0
    s_cbranch_scc1 mlp_154
    v_lshl_add_u32 v27, v1, 4, s70
    s_mov_b32 exec_hi, 0
    s_branch mls_155
mlp_154:
    s_sub_u32 s71, s60, 1
    s_and_b32 s71, s71, 3
    s_lshl_b32 s71, s71, 2
    s_lshl_b32 s71, 0xf, s71
    v_and_b32 v27, 3, v1
    v_lshl_add_u32 v27, v27, 4, s70
    s_mov_b32 exec_lo, s71
    s_mov_b32 exec_hi, 0
mls_155:
    v_add_u32 v28, 4194304, v27
    global_store_dwordx4 v28, v[212:215], s[88:89]
    global_store_dwordx4 v27, v[212:215], s[88:89] sc1
    s_mov_b64 exec, -1
    s_nop 1
mlf_152:
    s_bitcmp1_b32 s62, 5
    s_cbranch_scc0 mlk_157
    v_mov_b32 v26, 0
mlk_157:
    v_add_f32 v26, v26, v201
    s_bitcmp1_b32 s63, 5
    s_cbranch_scc0 mlf_156
    v_mov_b32 v212, v209
    v_mov_b32 v214, v26
    s_add_u32 s69, s40, s59
    s_lshl_b32 s70, s69, 9
    s_add_u32 s70, s70, 3145728
    s_cmp_lg_u32 s59, 0
    s_cbranch_scc1 mlp_158
    v_lshl_add_u32 v27, v1, 4, s70
    s_mov_b32 exec_hi, 0
    s_branch mls_159
mlp_158:
    s_sub_u32 s71, s59, 1
    s_and_b32 s71, s71, 3
    s_lshl_b32 s71, s71, 2
    s_lshl_b32 s71, 0xf, s71
    v_and_b32 v27, 3, v1
    v_lshl_add_u32 v27, v27, 4, s70
    s_mov_b32 exec_lo, s71
    s_mov_b32 exec_hi, 0
mls_159:
    v_add_u32 v28, 4194304, v27
    global_store_dwordx4 v28, v[212:215], s[88:89]
    global_store_dwordx4 v27, v[212:215], s[88:89] sc1
    s_mov_b64 exec, -1
    s_nop 1
mlf_156:
    s_bitcmp1_b32 s62, 4
    s_cbranch_scc0 mlk_161
    v_mov_b32 v26, 0
mlk_161:
    v_add_f32 v26, v26, v200
    s_bitcmp1_b32 s63, 4
    s_cbranch_scc0 mlf_160
    v_mov_b32 v212, v208
    v_mov_b32 v214, v26
    s_add_u32 s69, s40, s58
    s_lshl_b32 s70, s69, 9
    s_add_u32 s70, s70, 3145728
    s_cmp_lg_u32 s58, 0
    s_cbranch_scc1 mlp_162
    v_lshl_add_u32 v27, v1, 4, s70
    s_mov_b32 exec_hi, 0
    s_branch mls_163
mlp_162:
    s_sub_u32 s71, s58, 1
    s_and_b32 s71, s71, 3
    s_lshl_b32 s71, s71, 2
    s_lshl_b32 s71, 0xf, s71
    v_and_b32 v27, 3, v1
    v_lshl_add_u32 v27, v27, 4, s70
    s_mov_b32 exec_lo, s71
    s_mov_b32 exec_hi, 0
mls_163:
    v_add_u32 v28, 4194304, v27
    global_store_dwordx4 v28, v[212:215], s[88:89]
    global_store_dwordx4 v27, v[212:215], s[88:89] sc1
    s_mov_b64 exec, -1
    s_nop 1
mlf_160:
    s_bitcmp1_b32 s62, 3
    s_cbranch_scc0 mlk_165
    v_mov_b32 v26, 0
mlk_165:
    v_add_f32 v26, v26, v199
    s_bitcmp1_b32 s63, 3
    s_cbranch_scc0 mlf_164
    v_mov_b32 v212, v207
    v_mov_b32 v214, v26
    s_add_u32 s69, s40, s57
    s_lshl_b32 s70, s69, 9
    s_add_u32 s70, s70, 3145728
    s_cmp_lg_u32 s57, 0
    s_cbranch_scc1 mlp_166
    v_lshl_add_u32 v27, v1, 4, s70
    s_mov_b32 exec_hi, 0
    s_branch mls_167
mlp_166:
    s_sub_u32 s71, s57, 1
    s_and_b32 s71, s71, 3
    s_lshl_b32 s71, s71, 2
    s_lshl_b32 s71, 0xf, s71
    v_and_b32 v27, 3, v1
    v_lshl_add_u32 v27, v27, 4, s70
    s_mov_b32 exec_lo, s71
    s_mov_b32 exec_hi, 0
mls_167:
    v_add_u32 v28, 4194304, v27
    global_store_dwordx4 v28, v[212:215], s[88:89]
    global_store_dwordx4 v27, v[212:215], s[88:89] sc1
    s_mov_b64 exec, -1
    s_nop 1
mlf_164:
    s_bitcmp1_b32 s62, 2
    s_cbranch_scc0 mlk_169
    v_mov_b32 v26, 0
mlk_169:
    v_add_f32 v26, v26, v198
    s_bitcmp1_b32 s63, 2
    s_cbranch_scc0 mlf_168
    v_mov_b32 v212, v206
    v_mov_b32 v214, v26
    s_add_u32 s69, s40, s56
    s_lshl_b32 s70, s69, 9
    s_add_u32 s70, s70, 3145728
    s_cmp_lg_u32 s56, 0
    s_cbranch_scc1 mlp_170
    v_lshl_add_u32 v27, v1, 4, s70
    s_mov_b32 exec_hi, 0
    s_branch mls_171
mlp_170:
    s_sub_u32 s71, s56, 1
    s_and_b32 s71, s71, 3
    s_lshl_b32 s71, s71, 2
    s_lshl_b32 s71, 0xf, s71
    v_and_b32 v27, 3, v1
    v_lshl_add_u32 v27, v27, 4, s70
    s_mov_b32 exec_lo, s71
    s_mov_b32 exec_hi, 0
mls_171:
    v_add_u32 v28, 4194304, v27
    global_store_dwordx4 v28, v[212:215], s[88:89]
    global_store_dwordx4 v27, v[212:215], s[88:89] sc1
    s_mov_b64 exec, -1
    s_nop 1
mlf_168:
    s_bitcmp1_b32 s62, 1
    s_cbranch_scc0 mlk_173
    v_mov_b32 v26, 0
mlk_173:
    v_add_f32 v26, v26, v197
    s_bitcmp1_b32 s63, 1
    s_cbranch_scc0 mlf_172
    v_mov_b32 v212, v205
    v_mov_b32 v214, v26
    s_add_u32 s69, s40, s55
    s_lshl_b32 s70, s69, 9
    s_add_u32 s70, s70, 3145728
    s_cmp_lg_u32 s55, 0
    s_cbranch_scc1 mlp_174
    v_lshl_add_u32 v27, v1, 4, s70
    s_mov_b32 exec_hi, 0
    s_branch mls_175
mlp_174:
    s_sub_u32 s71, s55, 1
    s_and_b32 s71, s71, 3
    s_lshl_b32 s71, s71, 2
    s_lshl_b32 s71, 0xf, s71
    v_and_b32 v27, 3, v1
    v_lshl_add_u32 v27, v27, 4, s70
    s_mov_b32 exec_lo, s71
    s_mov_b32 exec_hi, 0
mls_175:
    v_add_u32 v28, 4194304, v27
    global_store_dwordx4 v28, v[212:215], s[88:89]
    global_store_dwordx4 v27, v[212:215], s[88:89] sc1
    s_mov_b64 exec, -1
    s_nop 1
mlf_172:
    s_bitcmp1_b32 s62, 0
    s_cbranch_scc0 mlk_177
    v_mov_b32 v26, 0
mlk_177:
    v_add_f32 v26, v26, v196
    s_bitcmp1_b32 s63, 0
    s_cbranch_scc0 mlf_176
    v_mov_b32 v212, v204
    v_mov_b32 v214, v26
    s_add_u32 s69, s40, s54
    s_lshl_b32 s70, s69, 9
    s_add_u32 s70, s70, 3145728
    s_cmp_lg_u32 s54, 0
    s_cbranch_scc1 mlp_178
    v_lshl_add_u32 v27, v1, 4, s70
    s_mov_b32 exec_hi, 0
    s_branch mls_179
mlp_178:
    s_sub_u32 s71, s54, 1
    s_and_b32 s71, s71, 3
    s_lshl_b32 s71, s71, 2
    s_lshl_b32 s71, 0xf, s71
    v_and_b32 v27, 3, v1
    v_lshl_add_u32 v27, v27, 4, s70
    s_mov_b32 exec_lo, s71
    s_mov_b32 exec_hi, 0
mls_179:
    v_add_u32 v28, 4194304, v27
    global_store_dwordx4 v28, v[212:215], s[88:89]
    global_store_dwordx4 v27, v[212:215], s[88:89] sc1
    s_mov_b64 exec, -1
    s_nop 1
mlf_176:
ml_151:
    s_cmp_lg_u32 s32, 7
    s_cbranch_scc1 w7_180
    s_waitcnt vmcnt(0)
w7_180:
    s_waitcnt lgkmcnt(0)
    s_barrier
    ds_read_b64_tr_b16 v[56:57], v17 offset:40960
    ds_read_b64_tr_b16 v[58:59], v17 offset:45056
    ds_read_b64_tr_b16 v[52:53], v17 offset:24576
    ds_read_b64_tr_b16 v[54:55], v17 offset:28672
    ds_read_b64_tr_b16 v[48:49], v17 offset:8192
    ds_read_b64_tr_b16 v[50:51], v17 offset:12288
    ds_read_b64_tr_b16 v[44:45], v16 offset:57344
    ds_read_b64_tr_b16 v[46:47], v16 offset:61440
    ds_read_b64_tr_b16 v[40:41], v16 offset:40960
    ds_read_b64_tr_b16 v[42:43], v16 offset:45056
    ds_read_b64_tr_b16 v[36:37], v16 offset:24576
    ds_read_b64_tr_b16 v[38:39], v16 offset:28672
    ds_read_b64_tr_b16 v[32:33], v16 offset:8192
    ds_read_b64_tr_b16 v[34:35], v16 offset:12288
    s_cmp_lg_u32 s61, 0x81
    s_cbranch_scc1 sbg_181
    s_waitcnt lgkmcnt(12)
    v_mfma_f32_16x16x32_bf16 v[176:179], v[56:59], v[112:115], v[176:179]
    v_mfma_f32_16x16x32_bf16 v[180:183], v[56:59], v[116:119], v[180:183]
    s_waitcnt lgkmcnt(10)
    v_mfma_f32_16x16x32_bf16 v[168:171], v[52:55], v[104:107], v[176:179]
    v_mfma_f32_16x16x32_bf16 v[172:175], v[52:55], v[108:111], v[180:183]
    s_waitcnt lgkmcnt(8)
    v_mfma_f32_16x16x32_bf16 v[160:163], v[48:51], v[96:99], v[168:171]
    v_mfma_f32_16x16x32_bf16 v[164:167], v[48:51], v[100:103], v[172:175]
    s_waitcnt lgkmcnt(6)
    v_mfma_f32_16x16x32_bf16 v[152:155], v[44:47], v[88:91], v[160:163]
    v_mfma_f32_16x16x32_bf16 v[156:159], v[44:47], v[92:95], v[164:167]
    s_waitcnt lgkmcnt(4)
    v_mfma_f32_16x16x32_bf16 v[144:147], v[40:43], v[80:83], v[152:155]
    v_mfma_f32_16x16x32_bf16 v[148:151], v[40:43], v[84:87], v[156:159]
    s_waitcnt lgkmcnt(2)
    v_mfma_f32_16x16x32_bf16 v[136:139], v[36:39], v[72:75], v[144:147]
    v_mfma_f32_16x16x32_bf16 v[140:143], v[36:39], v[76:79], v[148:151]
    s_waitcnt lgkmcnt(0)
    v_mfma_f32_16x16x32_bf16 v[128:131], v[32:35], v[64:67], v[136:139]
    v_mfma_f32_16x16x32_bf16 v[132:135], v[32:35], v[68:71], v[140:143]
    s_branch sbf_182
sbg_181:
    s_waitcnt lgkmcnt(12)
    s_bitcmp1_b32 s62, 6
    s_cbranch_scc1 ra_183
ra_183:
    v_mfma_f32_16x16x32_bf16 v[176:179], v[56:59], v[112:115], v[176:179]
    v_mfma_f32_16x16x32_bf16 v[180:183], v[56:59], v[116:119], v[180:183]
rb_184:
    s_waitcnt lgkmcnt(10)
    s_bitcmp1_b32 s62, 5
    s_cbranch_scc1 ra_185
    v_mfma_f32_16x16x32_bf16 v[168:171], v[52:55], v[104:107], v[176:179]
    v_mfma_f32_16x16x32_bf16 v[172:175], v[52:55], v[108:111], v[180:183]
    s_branch rb_186
ra_185:
    v_mfma_f32_16x16x32_bf16 v[168:171], v[52:55], v[104:107], v[168:171]
    v_mfma_f32_16x16x32_bf16 v[172:175], v[52:55], v[108:111], v[172:175]
rb_186:
    s_waitcnt lgkmcnt(8)
    s_bitcmp1_b32 s62, 4
    s_cbranch_scc1 ra_187
    v_mfma_f32_16x16x32_bf16 v[160:163], v[48:51], v[96:99], v[168:171]
    v_mfma_f32_16x16x32_bf16 v[164:167], v[48:51], v[100:103], v[172:175]
    s_branch rb_188
ra_187:
    v_mfma_f32_16x16x32_bf16 v[160:163], v[48:51], v[96:99], v[160:163]
    v_mfma_f32_16x16x32_bf16 v[164:167], v[48:51], v[100:103], v[164:167]
rb_188:
    s_waitcnt lgkmcnt(6)
    s_bitcmp1_b32 s62, 3
    s_cbranch_scc1 ra_189
    v_mfma_f32_16x16x32_bf16 v[152:155], v[44:47], v[88:91], v[160:163]
    v_mfma_f32_16x16x32_bf16 v[156:159], v[44:47], v[92:95], v[164:167]
    s_branch rb_190
ra_189:
    v_mfma_f32_16x16x32_bf16 v[152:155], v[44:47], v[88:91], v[152:155]
    v_mfma_f32_16x16x32_bf16 v[156:159], v[44:47], v[92:95], v[156:159]
rb_190:
    s_waitcnt lgkmcnt(4)
    s_bitcmp1_b32 s62, 2
    s_cbranch_scc1 ra_191
    v_mfma_f32_16x16x32_bf16 v[144:147], v[40:43], v[80:83], v[152:155]
    v_mfma_f32_16x16x32_bf16 v[148:151], v[40:43], v[84:87], v[156:159]
    s_branch rb_192
ra_191:
    v_mfma_f32_16x16x32_bf16 v[144:147], v[40:43], v[80:83], v[144:147]
    v_mfma_f32_16x16x32_bf16 v[148:151], v[40:43], v[84:87], v[148:151]
rb_192:
    s_waitcnt lgkmcnt(2)
    s_bitcmp1_b32 s62, 1
    s_cbranch_scc1 ra_193
    v_mfma_f32_16x16x32_bf16 v[136:139], v[36:39], v[72:75], v[144:147]
    v_mfma_f32_16x16x32_bf16 v[140:143], v[36:39], v[76:79], v[148:151]
    s_branch rb_194
ra_193:
    v_mfma_f32_16x16x32_bf16 v[136:139], v[36:39], v[72:75], v[136:139]
    v_mfma_f32_16x16x32_bf16 v[140:143], v[36:39], v[76:79], v[140:143]
rb_194:
    s_waitcnt lgkmcnt(0)
    s_bitcmp1_b32 s62, 0
    s_cbranch_scc1 ra_195
    v_mfma_f32_16x16x32_bf16 v[128:131], v[32:35], v[64:67], v[136:139]
    v_mfma_f32_16x16x32_bf16 v[132:135], v[32:35], v[68:71], v[140:143]
    s_branch rb_196
ra_195:
    v_mfma_f32_16x16x32_bf16 v[128:131], v[32:35], v[64:67], v[128:131]
    v_mfma_f32_16x16x32_bf16 v[132:135], v[32:35], v[68:71], v[132:135]
rb_196:
sbf_182:
    s_nop 7
    v_cvt_pk_bf16_f32 v224, v128, v129
    v_cvt_pk_bf16_f32 v226, v130, v131
    v_cvt_pk_bf16_f32 v228, v132, v133
    v_cvt_pk_bf16_f32 v230, v134, v135
    s_mov_b64 exec, s[94:95]
    global_store_dwordx4 v238, v[224:227], s[88:89]
    s_cmp_lg_u32 s54, 0
    s_cbranch_scc1 f0_197
    global_store_dwordx4 v239, v[228:231], s[88:89]
    global_store_dwordx4 v241, v[228:231], s[88:89] sc1
f0_197:
    s_cmp_eq_u32 s73, 0
    s_cbranch_scc1 f0_198
    global_store_dwordx4 v240, v[224:227], s[88:89] sc1
f0_198:
    s_mov_b64 exec, -1
    s_and_b32 s73, s63, 0xfe
    s_cbranch_scc0 L_consume
xp_199:
    s_ff1_i32_b32 s68, s73
    s_bitset0_b32 s73, s68
    s_mov_b32 m0, s68
    s_lshl_b32 s72, s68, 3
    s_movrels_b32 s71, s54
    s_set_gpr_idx_on s72, gpr_idx(SRC0,SRC1)
    s_nop 0
    v_cvt_pk_bf16_f32 v224, v128, v129
    v_cvt_pk_bf16_f32 v226, v130, v131
    s_set_gpr_idx_off
    s_add_u32 s69, s40, s71
    s_lshl_b32 s70, s69, 14
    s_sub_u32 s71, s71, 1
    s_and_b32 s69, s71, 3
    v_add_u32 v222, s70, v220
    v_cmp_eq_u32 vcc, s69, v221
    v_add_u32 v223, 4194304, v222
    s_mov_b64 exec, vcc
    global_store_dwordx4 v223, v[224:227], s[88:89]
    s_bitcmp1_b32 s100, s71
    s_cbranch_scc1 xpb_200
    global_store_dwordx4 v222, v[224:227], s[88:89] sc1
xpb_200:
    s_mov_b64 exec, -1
    s_nop 1
    s_cmp_lg_u32 s73, 0
    s_cbranch_scc1 xp_199
    s_branch L_consume
L_end:
    s_endpgm
.section .rodata,"a"
.p2align 6
.amdhsa_kernel standalone__paged_block_table_kv_radixattention__sampling_kernel
  .amdhsa_next_free_vgpr 256
  .amdhsa_next_free_sgpr 102
  .amdhsa_accum_offset 256
  .amdhsa_group_segment_fixed_size 0
  .amdhsa_kernarg_size 64
  .amdhsa_user_sgpr_count 2
  .amdhsa_user_sgpr_kernarg_segment_ptr 1
  .amdhsa_system_sgpr_workgroup_id_x 1
.end_amdhsa_kernel
```
